```python
import torch

def _softmax(x, axis=-1):
    return torch.softmax(x, dim=axis)
def _gelu(x):
    return torch.nn.functional.gelu(x, approximate="tanh")
def _silu(x):
    return torch.nn.functional.silu(x)
def _sigmoid(x):
    return torch.sigmoid(x)
def _layernorm(x, axis=-1, eps=1e-5):
    m = x.mean(dim=axis, keepdim=True)
    v = x.var(dim=axis, keepdim=True, unbiased=False)
    return (x - m) / torch.sqrt(v + eps)
def _scatter_add(tgt, idx, src, axis=0):
    return tgt.clone().index_add_(axis, idx, src)
def _segment_sum(src, seg, n):
    out = torch.zeros((n,) + src.shape[1:], dtype=src.dtype)
    return out.index_add_(0, seg, src)
def _pad(x, pw):
    flat = tuple(v for pair in reversed(pw) for v in pair)
    return torch.nn.functional.pad(x, flat)

kernel_name = 'recurrent_scan__sliding_local_dilated__mixer_token_mlp__prompt'

def setup_inputs():

    _w = (lambda a: (lambda t: t.to(torch.bfloat16) if t.is_floating_point() else t)(torch.as_tensor(a)))
    def _A_setup():
        B, S, D = 1, 2048, 448
        return {
            "x": _w((lambda *s: torch.randn(*s, dtype=torch.bfloat16) * 0.05)(B, S, D)),
            "wqkv": _w((lambda *s: torch.randn(*s, dtype=torch.bfloat16) * 0.2)(D, 3 * D)),
            "wo": _w((lambda *s: torch.randn(*s, dtype=torch.bfloat16) * 0.2)(D, D)),
        }
    _A_in = _A_setup()

    def _B_setup():
        B, S, D, F = 1, 2048, 448, 1792
        return {
            "x": _w((lambda *s: torch.randn(*s, dtype=torch.bfloat16) * 0.05)(B, S, D)),
            "w1": _w((lambda *s: torch.randn(*s, dtype=torch.bfloat16) * 0.8)(S, F) * (S ** -0.5)),
            "b1": _w((lambda *s: torch.randn(*s, dtype=torch.bfloat16) * 0.8)(F) * 0.02),
            "w2": _w((lambda *s: torch.randn(*s, dtype=torch.bfloat16) * 0.1)(F, S) * (F ** -0.5)),
            "b2": _w((lambda *s: torch.randn(*s, dtype=torch.bfloat16) * 0.1)(S) * 0.02),
        }
    _B_in = _B_setup()

    return {
        "A_x": _A_in["x"],
        "A_wqkv": _A_in["wqkv"],
        "A_wo": _A_in["wo"],
        "B_x": _B_in["x"],
        "B_w1": _B_in["w1"],
        "B_b1": _B_in["b1"],
        "B_w2": _B_in["w2"],
        "B_b2": _B_in["b2"],
    }

def reference(A_x, A_wqkv, A_wo, B_x, B_w1, B_b1, B_w2, B_b2):
    def _A_ref(x, wqkv, wo):
        B, S, D = x.shape
        H = 16; Dh = D // H
        W, dil = 8, 2
        qkv = (lambda x, *d: x.permute(*d))((x @ wqkv).reshape(B, S, 3, H, Dh), 2, 0, 3, 1, 4)
        q, k, v = qkv[0], qkv[1], qkv[2]
        scale = Dh ** -0.5
        pos = torch.arange(S)
        off = torch.arange(W) * dil
        idx = pos[:, None] - off[None, :]
        mask = idx >= 0
        idx_c = torch.where(mask, idx, 0).reshape(-1)
        kg = k[:, :, idx_c, :].reshape(B, H, S, W, Dh)
        vg = v[:, :, idx_c, :].reshape(B, H, S, W, Dh)
        logits = torch.einsum("bhsd,bhswd->bhsw", q, kg) * scale
        logits = torch.where(mask[None, None, :, :], logits, -1e9)
        attn = _softmax(logits, axis=-1)
        o = torch.einsum("bhsw,bhswd->bhsd", attn, vg)
        return (lambda x, *d: x.permute(*d))(o, 0, 2, 1, 3).reshape(B, S, D) @ wo

    def _B_ref(x, w1, b1, w2, b2):
        B, S, D = x.shape
        h = _layernorm(x, axis=-1)
        u = torch.einsum("bsd,sf->bdf", h, w1) + b1
        u = _gelu(u)
        y = torch.einsum("bdf,fs->bds", u, w2) + b2
        return (lambda x, *d: x.permute(*d))(y, 0, 2, 1)

    x = A_x
    xn = _layernorm(x, axis=-1)
    s = _A_ref(xn, A_wqkv, A_wo)
    g = _silu(_B_ref(xn, B_w1, B_b1, B_w2, B_b2))
    return x + s * g
```

```asm
; @launch grid=(256,1,1) block=(256,1,1) lds=163840
.amdgcn_target "amdgcn-amd-amdhsa--gfx950"
.text
.globl recurrent_scan__sliding_local_dilated__mixer_token_mlp__prompt_kernel
.p2align 8
.type recurrent_scan__sliding_local_dilated__mixer_token_mlp__prompt_kernel,@function
recurrent_scan__sliding_local_dilated__mixer_token_mlp__prompt_kernel:
    s_load_dwordx2 s[4:5], s[0:1], 0
    s_load_dwordx2 s[40:41], s[0:1], 80
    s_load_dwordx2 s[16:17], s[0:1], 32
    s_cmp_ge_u32 s2, 256
    s_cbranch_scc1 L_end
    s_getpc_b64 s[70:71]
L_pc:
    s_lshr_b32 s46, s2, 3
    s_mul_i32 s57, s46, 1280
    v_min_u32 v16, 9, v0
    v_lshl_add_u32 v16, v16, 7, s57
    v_min_u32 v16, L_code_end-L_pc-4, v16
    global_load_dword v255, v16, s[70:71]
    v_lshrrev_b32 v16, 6, v0
    v_and_b32 v14, 63, v0
    v_readfirstlane_b32 s44, v16
    v_lshlrev_b32 v1, 4, v14
    v_cmp_gt_u32 vcc, 56, v14
    v_bfrev_b32 v17, 2
    s_mov_b32 s6, 0x1c0000
    s_mov_b32 s7, 0x20000
    v_cndmask_b32 v18, v17, v1, vcc
    s_lshl_b32 s57, s2, 2
    s_add_u32 s57, s57, s44
    s_mul_i32 s62, s57, 1792
    s_mov_b32 s42, 0x10000000
    s_mov_b32 s43, 0x20000
    v_mov_b32 v15, 0
    s_lshl_b32 s57, s44, 8
    s_or_b32 s65, s57, s2
    s_cmp_lt_u32 s65, 4
    s_waitcnt lgkmcnt(0)
    s_cbranch_scc0 L_noinit
    v_mov_b32 v20, 0
    v_mov_b32 v21, 0
    v_mov_b32 v22, 0
    v_mov_b32 v23, 0
    s_lshl_b32 s57, s2, 12
    buffer_store_dwordx4 v[20:23], v1, s[40:43], s57 offen offset:0 sc1
    buffer_store_dwordx4 v[20:23], v1, s[40:43], s57 offen offset:1024 sc1
    buffer_store_dwordx4 v[20:23], v1, s[40:43], s57 offen offset:2048 sc1
    buffer_store_dwordx4 v[20:23], v1, s[40:43], s57 offen offset:3072 sc1
L_noinit:
    buffer_load_dwordx4 v[24:27], v18, s[4:7], s62 offen
    buffer_load_dwordx4 v[28:31], v18, s[4:7], s62 offen offset:896
    s_load_dwordx2 s[28:29], s[0:1], 56
    s_load_dwordx2 s[20:21], s[0:1], 40
    s_load_dwordx2 s[36:37], s[0:1], 72
    s_load_dwordx2 s[8:9], s[0:1], 8
    s_load_dwordx2 s[24:25], s[0:1], 48
    s_load_dwordx2 s[12:13], s[0:1], 16
    s_load_dwordx2 s[32:33], s[0:1], 64
    s_and_b32 s45, s2, 7
    s_mul_i32 s57, s45, 49
    s_add_u32 s57, s57, 1
    s_lshr_b32 s57, s57, 1
    s_add_u32 s57, s57, s46
    s_and_b32 s58, s45, 1
    s_sub_u32 s47, 25, s58
    s_mul_i32 s48, s57, 9363
    s_lshr_b32 s48, s48, 16
    s_mul_i32 s59, s48, 7
    s_sub_u32 s49, s57, s59
    s_mul_i32 s50, s49, 37
    s_lshr_b32 s50, s50, 4
    s_mov_b32 s18, 0x700000
    s_mov_b32 s19, 0x20000
    s_mul_i32 s58, s44, 1835008
    s_lshl_b32 s57, s48, 7
    s_add_u32 s57, s57, s58
    v_lshrrev_b32 v16, 3, v14
    v_and_b32 v17, 6, v16
    v_and_b32 v19, 7, v14
    v_xor_b32 v17, v17, v19
    v_lshl_add_u32 v17, v17, 4, s57
    v_and_b32 v19, 4, v16
    v_add_u32 v16, v16, v19
    v_mul_u32_u24 v16, 3584, v16
    v_add_u32 v2, v16, v17
    v_add_u32 v3, 56320, v2
    v_add_u32 v4, 12288, v2
    v_add_u32 v5, 68608, v2
    s_mul_i32 s64, s44, 25600
    s_mul_i32 s60, s50, 114688
    s_cmp_lt_u32 s46, s47
    s_cbranch_scc0 L_idle
    s_add_u32 m0, s64, 0
    s_nop 0
    buffer_load_dwordx4 v2, s[16:19], s60 offen offset:0  lds
    buffer_load_dwordx4 v3, s[16:19], s60 offen offset:1024  lds
    buffer_load_dwordx4 v4, s[16:19], s60 offen offset:2048  lds
    buffer_load_dwordx4 v5, s[16:19], s60 offen offset:3072  lds
    v_mov_b32 v61, 1
    s_mov_b32 s38, 0x100
    s_mov_b32 s39, 0x20000
    s_mov_b32 s10, 0x126000
    s_mov_b32 s11, 0x20000
    s_mov_b32 s14, 0x62000
    s_mov_b32 s15, 0x20000
    s_mov_b32 s22, 0xe00
    s_mov_b32 s23, 0x20000
    s_mov_b32 s26, 0x700000
    s_mov_b32 s27, 0x20000
    s_mov_b32 s30, 0x1000
    s_mov_b32 s31, 0x20000
    s_mov_b32 s34, 0x1c0000
    s_mov_b32 s35, 0x20000
    s_lshr_b32 s51, s46, 1
    s_and_b32 s59, s46, 1
    s_lshl_b32 s52, s45, 1
    s_add_u32 s52, s52, s59
    s_sub_u32 s58, s46, 0
    s_and_b32 s58, s58, 31
    s_mul_i32 s53, s58, 37
    s_lshr_b32 s53, s53, 8
    s_mul_i32 s59, s53, 7
    s_sub_u32 s54, s58, s59
    s_xor_b32 s55, s45, 1
    s_lshl_b32 s55, s55, 2
    s_xor_b32 s59, s53, 0
    s_add_u32 s55, s55, s59
    s_lshl_b32 s66, s2, 8
    s_lshl_b32 s59, s44, 2
    s_add_u32 s66, s66, s59
    s_add_u32 s66, s66, 65536
    s_lshl_b32 s57, s55, 2
    s_add_u32 s57, s57, s44
    s_lshl_b32 s57, s57, 5
    v_and_b32 v16, 15, v14
    v_lshlrev_b32 v16, 1, v16
    s_waitcnt lgkmcnt(0)
    buffer_load_ushort v126, v16, s[28:31], s57 offen
    v_lshrrev_b32 v16, 4, v14
    v_and_b32 v17, 3, v14
    v_lshlrev_b32 v16, 3, v16
    v_lshl_add_u32 v16, v17, 5, v16
    s_lshl_b32 s57, s48, 7
    buffer_load_dwordx2 v[120:121], v16, s[20:23], s57 offen
    v_lshrrev_b32 v16, 2, v14
    v_bfe_u32 v17, v14, 3, 2
    v_lshlrev_b32 v16, 7, v16
    v_and_b32 v19, 3, v14
    v_lshl_add_u32 v16, v19, 3, v16
    v_add_u32 v16, s64, v16
    v_xor_b32 v19, 0, v17
    v_lshl_add_u32 v6, v19, 5, v16
    v_xor_b32 v19, 1, v17
    v_lshl_add_u32 v7, v19, 5, v16
    v_xor_b32 v19, 2, v17
    v_lshl_add_u32 v8, v19, 5, v16
    v_xor_b32 v19, 3, v17
    v_lshl_add_u32 v9, v19, 5, v16
    s_mul_i32 s57, s44, 1824
    s_add_u32 s57, s57, 102400
    v_add_u32 v32, s57, v1
    v_bfe_u32 v17, v14, 2, 2
    v_and_b32 v19, 3, v14
    v_lshrrev_b32 v20, 4, v14
    v_mul_u32_u24 v33, 912, v17
    v_lshl_add_u32 v33, v19, 3, v33
    v_lshl_add_u32 v33, v20, 5, v33
    s_lshl_b32 s57, s44, 7
    s_add_u32 s57, s57, 102400
    v_add_u32 v33, s57, v33
    v_and_b32 v19, 15, v14
    v_lshlrev_b32 v19, 4, v19
    v_lshl_add_u32 v34, v20, 10, v19
    v_lshrrev_b32 v19, 5, v14
    s_lshl_b32 s57, s44, 3
    s_add_u32 s57, s57, 110592
    v_lshl_add_u32 v35, v19, 2, s57
    v_lshlrev_b32 v36, 2, v14
    v_add_u32 v37, 110592, v36
    s_lshr_b32 s57, s2, 2
    s_lshl_b32 s57, s57, 12
    s_and_b32 s58, s2, 3
    s_lshl_b32 s58, s58, 8
    s_add_u32 s57, s57, s58
    s_lshl_b32 s58, s44, 18
    s_add_u32 s57, s57, s58
    s_add_u32 s62, s57, 3145728
    s_add_u32 s63, s62, 1048576
    s_lshl_b32 s57, s2, 8
    s_add_u32 s57, s57, 65536
    s_cmp_eq_u32 s44, 3
    s_cselect_b32 s63, s57, s63
    s_cselect_b64 s[72:73], 0xffff, -1
    s_cselect_b32 s74, 0, -1
    s_lshl_b32 s69, s2, 5
    s_cmp_eq_u32 s44, 0
    s_cselect_b32 s69, s69, 268435456
    v_mov_b32 v38, 0x3f803f80
    s_waitcnt vmcnt(6)
    v_dot2_f32_bf16 v20, v24, v38, 0
    v_dot2_f32_bf16 v21, v28, v38, 0
    v_dot2_f32_bf16 v20, v25, v38, v20
    v_dot2_f32_bf16 v21, v29, v38, v21
    v_dot2_f32_bf16 v20, v26, v38, v20
    v_dot2_f32_bf16 v21, v30, v38, v21
    v_dot2_f32_bf16 v20, v27, v38, v20
    v_dot2_f32_bf16 v21, v31, v38, v21
    v_lshlrev_b32 v40, 16, v24
    v_and_b32 v41, 0xffff0000, v24
    v_lshlrev_b32 v42, 16, v25
    v_and_b32 v43, 0xffff0000, v25
    v_permlane32_swap_b32 v20, v21
    v_add_f32 v20, v20, v21
    v_mov_b32 v22, v20
    v_lshlrev_b32 v44, 16, v26
    v_and_b32 v45, 0xffff0000, v26
    v_permlane16_swap_b32 v20, v22
    v_add_f32 v20, v20, v22
    v_lshlrev_b32 v46, 16, v27
    v_and_b32 v47, 0xffff0000, v27
    v_add_f32_dpp v20, v20, v20 row_ror:8 row_mask:0xf bank_mask:0xf
    v_lshlrev_b32 v48, 16, v28
    v_and_b32 v49, 0xffff0000, v28
    v_add_f32_dpp v20, v20, v20 row_ror:4 row_mask:0xf bank_mask:0xf
    v_lshlrev_b32 v50, 16, v29
    v_and_b32 v51, 0xffff0000, v29
    v_add_f32_dpp v20, v20, v20 row_ror:2 row_mask:0xf bank_mask:0xf
    v_lshlrev_b32 v52, 16, v30
    v_and_b32 v53, 0xffff0000, v30
    v_add_f32_dpp v20, v20, v20 row_ror:1 row_mask:0xf bank_mask:0xf
    v_lshlrev_b32 v54, 16, v31
    v_and_b32 v55, 0xffff0000, v31
    v_mul_f32 v20, 0xbb124925, v20
    s_nop 0
    v_readlane_b32 s76, v20, 0
    v_readlane_b32 s78, v20, 32
    s_mov_b32 exec_hi, 0x00ffffff
    v_pk_add_f32 v[40:41], v[40:41], s[76:77] op_sel_hi:[1,0]
    v_pk_add_f32 v[42:43], v[42:43], s[76:77] op_sel_hi:[1,0]
    v_pk_add_f32 v[44:45], v[44:45], s[76:77] op_sel_hi:[1,0]
    v_pk_add_f32 v[46:47], v[46:47], s[76:77] op_sel_hi:[1,0]
    v_pk_add_f32 v[48:49], v[48:49], s[78:79] op_sel_hi:[1,0]
    v_pk_add_f32 v[50:51], v[50:51], s[78:79] op_sel_hi:[1,0]
    v_pk_add_f32 v[52:53], v[52:53], s[78:79] op_sel_hi:[1,0]
    v_pk_add_f32 v[54:55], v[54:55], s[78:79] op_sel_hi:[1,0]
    s_mov_b32 exec_hi, -1
    v_pk_mul_f32 v[20:21], v[40:41], v[40:41]
    v_pk_mul_f32 v[22:23], v[48:49], v[48:49]
    v_pk_fma_f32 v[20:21], v[42:43], v[42:43], v[20:21]
    v_pk_fma_f32 v[22:23], v[50:51], v[50:51], v[22:23]
    v_pk_fma_f32 v[20:21], v[44:45], v[44:45], v[20:21]
    v_pk_fma_f32 v[22:23], v[52:53], v[52:53], v[22:23]
    v_pk_fma_f32 v[20:21], v[46:47], v[46:47], v[20:21]
    v_pk_fma_f32 v[22:23], v[54:55], v[54:55], v[22:23]
    v_add_f32 v20, v20, v21
    v_add_f32 v21, v22, v23
    v_mov_b32 v23, 0x3727c5ac
    s_nop 0
    v_permlane32_swap_b32 v20, v21
    v_add_f32 v20, v20, v21
    v_mov_b32 v22, v20
    s_nop 1
    v_permlane16_swap_b32 v20, v22
    v_add_f32 v20, v20, v22
    s_nop 1
    v_add_f32_dpp v20, v20, v20 row_ror:8 row_mask:0xf bank_mask:0xf
    s_nop 1
    v_add_f32_dpp v20, v20, v20 row_ror:4 row_mask:0xf bank_mask:0xf
    s_nop 1
    v_add_f32_dpp v20, v20, v20 row_ror:2 row_mask:0xf bank_mask:0xf
    s_nop 1
    v_add_f32_dpp v20, v20, v20 row_ror:1 row_mask:0xf bank_mask:0xf
    v_mul_f32 v20, 0x3b124925, v20
    v_add_f32 v21, v20, v23
    v_rsq_f32 v21, v21
    s_nop 0
    v_mul_f32 v20, v20, v21
    v_fma_f32 v20, v20, v21, v23
    v_rsq_f32 v22, v20
    s_nop 0
    v_mul_f32 v21, v21, v22
    v_mul_f32 v20, v20, v22
    v_readlane_b32 s76, v21, 0
    v_readlane_b32 s78, v21, 32
    ds_write_b32 v35, v20
    v_pk_mul_f32 v[40:41], v[40:41], s[76:77] op_sel_hi:[1,0]
    v_pk_mul_f32 v[42:43], v[42:43], s[76:77] op_sel_hi:[1,0]
    v_pk_mul_f32 v[44:45], v[44:45], s[76:77] op_sel_hi:[1,0]
    v_pk_mul_f32 v[46:47], v[46:47], s[76:77] op_sel_hi:[1,0]
    v_cvt_pk_bf16_f32 v24, v40, v41
    v_cvt_pk_bf16_f32 v25, v42, v43
    v_cvt_pk_bf16_f32 v26, v44, v45
    v_cvt_pk_bf16_f32 v27, v46, v47
    s_mov_b32 exec_hi, 0x00ffffff
    ds_write_b128 v32, v[24:27]
    v_pk_mul_f32 v[48:49], v[48:49], s[78:79] op_sel_hi:[1,0]
    v_pk_mul_f32 v[50:51], v[50:51], s[78:79] op_sel_hi:[1,0]
    v_pk_mul_f32 v[52:53], v[52:53], s[78:79] op_sel_hi:[1,0]
    v_pk_mul_f32 v[54:55], v[54:55], s[78:79] op_sel_hi:[1,0]
    v_cvt_pk_bf16_f32 v28, v48, v49
    v_cvt_pk_bf16_f32 v29, v50, v51
    v_cvt_pk_bf16_f32 v30, v52, v53
    v_cvt_pk_bf16_f32 v31, v54, v55
    ds_write_b128 v32, v[28:31] offset:912
    s_mov_b32 exec_hi, -1
    s_waitcnt lgkmcnt(0)
    s_barrier
    ds_read_b64_tr_b16 v[40:41], v33
    ds_read_b64_tr_b16 v[42:43], v33 offset:3648
    ds_read_b64_tr_b16 v[44:45], v33 offset:512
    ds_read_b64_tr_b16 v[46:47], v33 offset:4160
    ds_read_b32 v48, v37
    s_waitcnt lgkmcnt(3)
    buffer_store_dwordx4 v[40:43], v34, s[40:43], s62 offen sc1
    s_waitcnt lgkmcnt(1)
    v_and_b32 v44, s74, v44
    v_and_b32 v45, s74, v45
    v_and_b32 v46, s74, v46
    v_and_b32 v47, s74, v47
    s_mov_b64 exec, s[72:73]
    buffer_store_dwordx4 v[44:47], v34, s[40:43], s63 offen sc1
    s_mov_b64 exec, -1
    s_waitcnt lgkmcnt(0)
    s_lshl_b32 s57, s65, 2
    s_cmp_lt_u32 s65, 4
    s_cselect_b32 s57, s57, 256
    s_mov_b64 exec, 1
    buffer_store_dword v61, v15, s[36:39], s57 offen sc1
    s_mov_b64 exec, -1
    s_add_u32 s60, s60, 114688
    s_cmp_eq_u32 s60, 1835008
    s_cselect_b32 s60, 0, s60
    s_add_u32 m0, s64, 4096
    s_nop 0
    buffer_load_dwordx4 v2, s[16:19], s60 offen offset:0  lds
    buffer_load_dwordx4 v3, s[16:19], s60 offen offset:1024  lds
    buffer_load_dwordx4 v4, s[16:19], s60 offen offset:2048  lds
    buffer_load_dwordx4 v5, s[16:19], s60 offen offset:3072  lds
    s_add_u32 s60, s60, 114688
    s_cmp_eq_u32 s60, 1835008
    s_cselect_b32 s60, 0, s60
    s_add_u32 m0, s64, 8192
    s_nop 0
    buffer_load_dwordx4 v2, s[16:19], s60 offen offset:0  lds
    buffer_load_dwordx4 v3, s[16:19], s60 offen offset:1024  lds
    buffer_load_dwordx4 v4, s[16:19], s60 offen offset:2048  lds
    buffer_load_dwordx4 v5, s[16:19], s60 offen offset:3072  lds
    s_add_u32 s60, s60, 114688
    s_cmp_eq_u32 s60, 1835008
    s_cselect_b32 s60, 0, s60
    s_add_u32 m0, s64, 12288
    s_nop 0
    buffer_load_dwordx4 v2, s[16:19], s60 offen offset:0  lds
    buffer_load_dwordx4 v3, s[16:19], s60 offen offset:1024  lds
    s_waitcnt vmcnt(11)
    s_barrier
    s_mov_b64 exec, 0xff
    buffer_store_dword v48, v36, s[40:43], s69 offen offset:0 sc1
    s_mov_b64 exec, -1
    s_lshl_b32 s57, s44, 11
    v_add_u32 v62, s57, v1
    s_lshr_b32 s57, s52, 2
    s_mul_i32 s57, s57, 1792
    s_add_u32 s57, s57, 8192
    buffer_load_dwordx4 v4, s[16:19], s60 offen offset:2048  lds
    s_lshl_b32 s58, s44, 28
    s_add_u32 s57, s57, s58
    v_min_u32 v63, 55, v14
    v_lshl_add_u32 v63, v63, 5, s57
    s_lshl_b32 s58, s49, 18
    s_lshl_b32 s57, s44, 16
    buffer_load_dwordx4 v5, s[16:19], s60 offen offset:3072  lds
    s_add_u32 s60, s60, 114688
    s_cmp_eq_u32 s60, 1835008
    s_cselect_b32 s60, 0, s60
    s_add_u32 s58, s58, s57
    s_add_u32 s58, s58, 3145728
    s_add_u32 m0, s64, 16384
    s_nop 0
    buffer_load_dwordx4 v2, s[16:19], s60 offen offset:0  lds
    v_add_u32 v10, s58, v1
    s_lshl_b32 s50, s50, 2
    s_add_u32 s50, s50, s44
    s_lshl_b32 s50, s50, 10
    s_mul_i32 s59, s52, 75264
    s_add_u32 s59, s59, 5242880
    buffer_load_dwordx4 v3, s[16:19], s60 offen offset:1024  lds
    s_mul_i32 s8, s44, 18432
    s_add_u32 s67, s59, s8
    s_lshl_b32 s57, s44, 10
    s_add_u32 s9, s57, 75776
    s_add_u32 s57, s57, 71680
    s_add_u32 s20, s59, s57
    buffer_load_dwordx4 v4, s[16:19], s60 offen offset:2048  lds
    s_add_u32 s10, s9, 12288
    s_cmp_lt_u32 s44, 2
    s_cselect_b32 s10, s10, s57
    s_lshr_b32 s58, s44, 1
    s_lshl_b32 s57, s51, 2
    s_add_u32 s59, s57, s44
    buffer_load_dwordx4 v5, s[16:19], s60 offen offset:3072  lds
    s_add_u32 s60, s60, 114688
    s_cmp_eq_u32 s60, 1835008
    s_cselect_b32 s60, 0, s60
    s_lshl_b32 s59, s59, 12
    s_add_u32 s3, s59, 3145728
    s_add_u32 m0, s64, 20480
    s_nop 0
    buffer_load_dwordx4 v2, s[16:19], s60 offen offset:0  lds
    s_max_u32 s57, s57, 1
    s_sub_u32 s57, s57, 1
    s_lshl_b32 s57, s57, 12
    s_add_u32 s57, s57, 3146240
    s_lshl_b32 s59, s44, 11
    s_add_u32 s11, s57, s59
    buffer_load_dwordx4 v3, s[16:19], s60 offen offset:1024  lds
    s_add_u32 s11, s11, 1572864
    s_cmp_lt_u32 s44, 2
    s_cselect_b32 s11, s11, s20
    s_lshl_b32 s58, s58, 18
    ds_read_b64_tr_b16 a[0:1], v6 offset:0
    ds_read_b64_tr_b16 a[4:5], v7 offset:0
    s_add_u32 s57, s57, s58
    buffer_load_dwordx4 v4, s[16:19], s60 offen offset:2048  lds
    s_and_b32 s58, s44, 1
    s_lshl_b32 s58, s58, 11
    s_add_u32 s69, s57, s58
    ds_read_b64_tr_b16 a[8:9], v8 offset:0
    v_lshrrev_b32 v16, 1, v14
    ds_read_b64_tr_b16 a[12:13], v9 offset:0
    buffer_load_dwordx4 v5, s[16:19], s60 offen offset:3072  lds
    v_and_b32 v16, 8, v16
    s_add_u32 s60, s60, 114688
    s_cmp_eq_u32 s60, 1835008
    s_cselect_b32 s60, 0, s60
    s_add_u32 m0, s64, 0
    v_xor_b32 v16, v16, v14
    ds_read_b64_tr_b16 a[2:3], v6 offset:2048
    ds_read_b64_tr_b16 a[6:7], v7 offset:2048
    v_lshlrev_b32 v57, 4, v16
    s_waitcnt lgkmcnt(2)
    buffer_load_dwordx4 v2, s[16:19], s60 offen offset:0  lds
    v_and_b32 v16, 32, v14
    v_lshl_add_u32 v59, v16, 4, v57
    s_lshl_b32 s57, s51, 2
    ds_read_b64_tr_b16 a[10:11], v8 offset:2048
    s_add_u32 s57, s57, s44
    ds_read_b64_tr_b16 a[14:15], v9 offset:2048
    buffer_load_dwordx4 v3, s[16:19], s60 offen offset:1024  lds
    s_lshl_b32 s57, s57, 5
    s_sub_u32 s57, s57, 16
    v_add_u32 v16, s57, v14
    s_waitcnt vmcnt(21)
    ds_read_b64_tr_b16 a[16:17], v6 offset:4096
    ds_read_b64_tr_b16 a[20:21], v7 offset:4096
    v_max_i32 v16, 0, v16
    s_waitcnt lgkmcnt(2)
    buffer_load_dwordx4 v4, s[16:19], s60 offen offset:2048  lds
    v_lshlrev_b32 v60, 2, v16
    s_mul_i32 s57, s44, 12288
    s_add_u32 s57, s57, 102400
    ds_read_b64_tr_b16 a[24:25], v8 offset:4096
    v_lshrrev_b32 v16, 2, v14
    ds_read_b64_tr_b16 a[28:29], v9 offset:4096
    buffer_load_dwordx4 v5, s[16:19], s60 offen offset:3072  lds
    v_bfe_u32 v17, v14, 1, 1
    s_add_u32 s60, s60, 114688
    s_cmp_eq_u32 s60, 1835008
    s_cselect_b32 s60, 0, s60
    s_add_u32 m0, s64, 4096
    v_mul_u32_u24 v17, 24, v17
    s_waitcnt vmcnt(21)
    ds_read_b64_tr_b16 a[18:19], v6 offset:6144
    ds_read_b64_tr_b16 a[22:23], v7 offset:6144
    v_xor_b32 v16, v16, v17
    s_waitcnt lgkmcnt(2)
    buffer_load_dwordx4 v2, s[16:19], s60 offen offset:0  lds
    v_and_b32 v17, 1, v14
    v_lshlrev_b32 v17, 3, v17
    v_lshl_add_u32 v16, v16, 4, v17
    ds_read_b64_tr_b16 a[26:27], v8 offset:6144
    v_add_u32 v58, s57, v16
    ds_read_b64_tr_b16 a[30:31], v9 offset:6144
    buffer_load_dwordx4 v3, s[16:19], s60 offen offset:1024  lds
    v_add_u32 v49, 75776, v16
    v_add_u32 v11, 48384, v1
    v_and_b32 v16, 15, v14
    s_waitcnt vmcnt(21)
    ds_read_b64_tr_b16 a[32:33], v6 offset:8192
    ds_read_b64_tr_b16 a[36:37], v7 offset:8192
    v_subrev_u32 v17, 12, v16
    s_waitcnt lgkmcnt(2)
    buffer_load_dwordx4 v4, s[16:19], s60 offen offset:2048  lds
    v_min_u32 v16, v16, v17
    v_add_u32 v17, 12, v16
    v_xor_b32 v17, v17, v14
    ds_read_b64_tr_b16 a[40:41], v8 offset:8192
    v_bfe_u32 v17, v17, 4, 1
    ds_read_b64_tr_b16 a[44:45], v9 offset:8192
    buffer_load_dwordx4 v5, s[16:19], s60 offen offset:3072  lds
    v_mad_u32_u24 v16, v17, 12, v16
    s_add_u32 s60, s60, 114688
    s_cmp_eq_u32 s60, 1835008
    s_cselect_b32 s60, 0, s60
    s_add_u32 m0, s64, 8192
    v_lshrrev_b32 v17, 5, v14
    s_waitcnt vmcnt(21)
    ds_read_b64_tr_b16 a[34:35], v6 offset:10240
    ds_read_b64_tr_b16 a[38:39], v7 offset:10240
    v_mad_u32_u24 v16, v17, 24, v16
    s_waitcnt lgkmcnt(2)
    buffer_load_dwordx4 v2, s[16:19], s60 offen offset:0  lds
    v_lshlrev_b32 v16, 4, v16
    v_add_u32 v56, 3072, v16
    s_lshr_b32 s57, s44, 1
    ds_read_b64_tr_b16 a[42:43], v8 offset:10240
    s_add_u32 s57, s57, 1
    ds_read_b64_tr_b16 a[46:47], v9 offset:10240
    buffer_load_dwordx4 v3, s[16:19], s60 offen offset:1024  lds
    s_lshl_b32 s58, s57, 10
    s_mul_i32 s57, s57, 768
    v_add_u32 v16, s58, v1
    s_waitcnt vmcnt(21)
    ds_read_b64_tr_b16 a[48:49], v6 offset:12288
    ds_read_b64_tr_b16 a[52:53], v7 offset:12288
    v_add_u32 v17, s57, v56
    s_waitcnt lgkmcnt(2)
    buffer_load_dwordx4 v4, s[16:19], s60 offen offset:2048  lds
    s_bitcmp1_b32 s44, 0
    s_cselect_b64 s[78:79], -1, 0
    v_cndmask_b32 v12, v16, v17, s[78:79]
    ds_read_b64_tr_b16 a[56:57], v8 offset:12288
    v_add_u32 v13, 48384, v12
    ds_read_b64_tr_b16 a[60:61], v9 offset:12288
    buffer_load_dwordx4 v5, s[16:19], s60 offen offset:3072  lds
    s_mov_b32 s70, 0xaaaaaaaa
    s_add_u32 s60, s60, 114688
    s_cmp_eq_u32 s60, 1835008
    s_cselect_b32 s60, 0, s60
    s_add_u32 m0, s64, 12288
    s_mov_b32 s71, 0xaaaaaaaa
    s_waitcnt vmcnt(20)
    ds_read_b64_tr_b16 a[50:51], v6 offset:14336
    ds_read_b64_tr_b16 a[54:55], v7 offset:14336
    s_mov_b32 s72, 0xfff0ffff
    s_waitcnt lgkmcnt(2)
    buffer_load_dwordx4 v2, s[16:19], s60 offen offset:0  lds
    s_mov_b32 s73, 0xf000ff00
    s_mov_b32 s74, 0xffc0fffc
    s_mov_b32 s75, 0xc000fc00
    ds_read_b64_tr_b16 a[58:59], v8 offset:14336
    v_mov_b32 v16, 0xffff
    ds_read_b64_tr_b16 a[62:63], v9 offset:14336
    buffer_load_dwordx4 v3, s[16:19], s60 offen offset:1024  lds
    v_mov_b32 v17, 0xffff0000
    v_cndmask_b32 v16, v16, v17, s[70:71]
    v_cndmask_b32 v240, v16, v15, s[72:73]
    s_waitcnt vmcnt(20)
    ds_read_b64_tr_b16 a[64:65], v6 offset:16384
    ds_read_b64_tr_b16 a[68:69], v7 offset:16384
    v_cndmask_b32 v241, v16, v15, s[74:75]
    s_waitcnt lgkmcnt(2)
    buffer_load_dwordx4 v4, s[16:19], s60 offen offset:2048  lds
    v_cndmask_b32 v242, v15, v16, s[72:73]
    v_cndmask_b32 v243, v15, v16, s[74:75]
    s_or_b32 s57, s51, s44
    ds_read_b64_tr_b16 a[72:73], v8 offset:16384
    s_cmp_eq_u32 s57, 0
    s_cselect_b32 s57, 0xf149f2ca, 0
    v_mov_b32 v244, s57
    ds_read_b64_tr_b16 a[76:77], v9 offset:16384
    buffer_load_dwordx4 v5, s[16:19], s60 offen offset:3072  lds
    v_mov_b32 v245, s57
    s_add_u32 s60, s60, 114688
    s_cmp_eq_u32 s60, 1835008
    s_cselect_b32 s60, 0, s60
    s_add_u32 m0, s64, 16384
    v_mov_b32 v246, s57
    s_waitcnt vmcnt(20)
    ds_read_b64_tr_b16 a[66:67], v6 offset:18432
    ds_read_b64_tr_b16 a[70:71], v7 offset:18432
    v_mov_b32 v247, s57
    s_waitcnt lgkmcnt(2)
    buffer_load_dwordx4 v2, s[16:19], s60 offen offset:0  lds
    v_and_b32 v18, 15, v14
    v_lshlrev_b32 v53, 2, v18
    v_lshrrev_b32 v16, 4, v14
    ds_read_b64_tr_b16 a[74:75], v8 offset:18432
    v_lshlrev_b32 v16, 4, v16
    ds_read_b64_tr_b16 a[78:79], v9 offset:18432
    buffer_load_dwordx4 v3, s[16:19], s60 offen offset:1024  lds
    v_and_b32 v17, 1, v14
    v_lshl_add_u32 v16, v17, 2, v16
    v_add_u32 v17, 64, v16
    s_waitcnt vmcnt(20)
    ds_read_b64_tr_b16 a[80:81], v6 offset:20480
    ds_read_b64_tr_b16 a[84:85], v7 offset:20480
    v_cndmask_b32 v54, v16, v17, s[72:73]
    s_waitcnt lgkmcnt(2)
    buffer_load_dwordx4 v4, s[16:19], s60 offen offset:2048  lds
    v_cndmask_b32 v55, v16, v17, s[74:75]
    s_lshl_b32 s57, s44, 11
    s_add_u32 s57, s57, 151552
    ds_read_b64_tr_b16 a[88:89], v8 offset:20480
    v_add_u32 v50, s57, v1
    ds_read_b64_tr_b16 a[92:93], v9 offset:20480
    buffer_load_dwordx4 v5, s[16:19], s60 offen offset:3072  lds
    s_lshr_b32 s57, s44, 1
    s_add_u32 s60, s60, 114688
    s_cmp_eq_u32 s60, 1835008
    s_cselect_b32 s60, 0, s60
    s_add_u32 m0, s64, 20480
    s_lshl_b32 s57, s57, 10
    s_waitcnt vmcnt(20)
    ds_read_b64_tr_b16 a[82:83], v6 offset:22528
    ds_read_b64_tr_b16 a[86:87], v7 offset:22528
    s_and_b32 s58, s44, 1
    s_waitcnt lgkmcnt(2)
    buffer_load_dwordx4 v2, s[16:19], s60 offen offset:0  lds
    s_lshl_b32 s58, s58, 3
    s_add_u32 s57, s57, s58
    s_add_u32 s57, s57, 151552
    ds_read_b64_tr_b16 a[90:91], v8 offset:22528
    v_add_u32 v51, s57, v1
    ds_read_b64_tr_b16 a[94:95], v9 offset:22528
    buffer_load_dwordx4 v3, s[16:19], s60 offen offset:1024  lds
    s_lshl_b32 s57, s51, 2
    s_add_u32 s57, s57, s44
    s_mul_i32 s57, s57, 34816
    s_waitcnt vmcnt(20)
    ds_read_b64_tr_b16 a[96:97], v6 offset:0
    ds_read_b64_tr_b16 a[100:101], v7 offset:0
    s_lshl_b32 s58, s52, 10
    s_waitcnt lgkmcnt(2)
    buffer_load_dwordx4 v4, s[16:19], s60 offen offset:2048  lds
    s_add_u32 s57, s57, s58
    s_add_u32 s23, s57, 9437184
    s_add_u32 s63, s23, 17408
    ds_read_b64_tr_b16 a[104:105], v8 offset:0
    s_cmp_lt_u32 s44, 2
    s_cselect_b64 s[78:79], -1, 0
    s_lshl_b32 s57, s55, 2
    ds_read_b64_tr_b16 a[108:109], v9 offset:0
    buffer_load_dwordx4 v5, s[16:19], s60 offen offset:3072  lds
    s_add_u32 s59, s57, s44
    s_lshl_b32 s58, s54, 7
    s_mul_i32 s57, s59, 14336
    s_add_u32 s56, s57, s58
    s_mul_i32 s57, s44, 100352
    s_add_u32 s22, s57, s58
    buffer_load_dwordx4 v[20:23], v15, s[36:39], 0 offen sc1
    s_add_u32 s60, s60, 114688
    s_cmp_eq_u32 s60, 1835008
    s_cselect_b32 s60, 0, s60
    s_mul_i32 s21, s44, 14336
    s_add_u32 m0, s64, 0
    s_waitcnt vmcnt(21)
    ds_read_b64_tr_b16 a[98:99], v6 offset:2048
    s_mul_i32 s57, s59, 17408
    ds_read_b64_tr_b16 a[102:103], v7 offset:2048
    s_waitcnt lgkmcnt(2)
    buffer_load_dwordx4 v2, s[16:19], s60 offen offset:0  lds
    s_add_u32 s47, s57, 9437184
    s_mul_i32 s58, s54, 229376
    s_mul_i32 s57, s44, 14336
    ds_read_b64_tr_b16 a[106:107], v8 offset:2048
    s_add_u32 s58, s58, s57
    ds_read_b64_tr_b16 a[110:111], v9 offset:2048
    buffer_load_dwordx4 v3, s[16:19], s60 offen offset:1024  lds
    s_add_u32 s68, s58, 7340032
    v_lshrrev_b32 v16, 3, v14
    v_and_b32 v17, 6, v16
    s_waitcnt vmcnt(21)
    ds_read_b64_tr_b16 a[112:113], v6 offset:4096
    ds_read_b64_tr_b16 a[116:117], v7 offset:4096
    v_and_b32 v19, 7, v14
    s_waitcnt lgkmcnt(2)
    buffer_load_dwordx4 v4, s[16:19], s60 offen offset:2048  lds
    v_xor_b32 v17, v17, v19
    v_mul_u32_u24 v16, 896, v16
    v_lshl_add_u32 v52, v17, 4, v16
    ds_read_b64_tr_b16 a[120:121], v8 offset:4096
    v_lshl_add_u32 v0, v19, 4, v16
    ds_read_b64_tr_b16 a[124:125], v9 offset:4096
    buffer_load_dwordx4 v5, s[16:19], s60 offen offset:3072  lds
    s_lshr_b32 s57, s59, 3
    s_add_u32 s60, s60, 114688
    s_cmp_eq_u32 s60, 1835008
    s_cselect_b32 s60, 0, s60
    s_add_u32 m0, s64, 4096
    s_lshl_b32 s57, s57, 12
    s_waitcnt vmcnt(21)
    ds_read_b64_tr_b16 a[114:115], v6 offset:6144
    ds_read_b64_tr_b16 a[118:119], v7 offset:6144
    s_bfe_u32 s58, s59, 0x20001
    s_waitcnt lgkmcnt(2)
    buffer_load_dwordx4 v2, s[16:19], s60 offen offset:0  lds
    s_lshl_b32 s58, s58, 2
    s_add_u32 s57, s57, s58
    s_add_u32 s57, s57, 65664
    ds_read_b64_tr_b16 a[122:123], v8 offset:6144
    v_lshl_add_u32 v127, v18, 8, s57
    ds_read_b64_tr_b16 a[126:127], v9 offset:6144
    buffer_load_dwordx4 v3, s[16:19], s60 offen offset:1024  lds
    s_waitcnt vmcnt(21)
    ds_read_b64_tr_b16 a[128:129], v6 offset:8192
    ds_read_b64_tr_b16 a[132:133], v7 offset:8192
    s_waitcnt lgkmcnt(2)
    buffer_load_dwordx4 v4, s[16:19], s60 offen offset:2048  lds
    ds_read_b64_tr_b16 a[136:137], v8 offset:8192
    ds_read_b64_tr_b16 a[140:141], v9 offset:8192
    buffer_load_dwordx4 v5, s[16:19], s60 offen offset:3072  lds
    s_waitcnt vmcnt(8)
    v_min3_u32 v20, v20, v21, v22
    v_min_u32 v20, v20, v23
    v_cmp_eq_u32 vcc, 0, v20
    s_nop 4
    s_cbranch_vccnz L_spin_1
L_go_2:
    buffer_load_dwordx4 v[24:27], v62, s[40:43], 0 offen offset:0 sc1
    buffer_load_dwordx4 v[28:31], v62, s[40:43], 0 offen offset:1024 sc1
    v_mov_b32 v122, 0x10000
    s_add_u32 s60, s60, 114688
    s_cmp_eq_u32 s60, 1835008
    s_cselect_b32 s60, 0, s60
    s_add_u32 m0, s64, 8192
    v_mov_b32 v123, 0xffff0000
    ds_read_b64_tr_b16 a[130:131], v6 offset:10240
    ds_read_b64_tr_b16 a[134:135], v7 offset:10240
    v_mul_u32_u24_dpp v64, v120, v122 quad_perm:[0,0,0,0] row_mask:0xf bank_mask:0xf
    s_waitcnt lgkmcnt(2)
    buffer_load_dwordx4 v2, s[16:19], s60 offen offset:0 nt lds
    v_and_b32_dpp v65, v120, v123 quad_perm:[0,0,0,0] row_mask:0xf bank_mask:0xf
    v_mul_u32_u24_dpp v66, v121, v122 quad_perm:[0,0,0,0] row_mask:0xf bank_mask:0xf
    v_and_b32_dpp v67, v121, v123 quad_perm:[0,0,0,0] row_mask:0xf bank_mask:0xf
    ds_read_b64_tr_b16 a[138:139], v8 offset:10240
    v_mul_u32_u24_dpp v68, v120, v122 quad_perm:[1,1,1,1] row_mask:0xf bank_mask:0xf
    ds_read_b64_tr_b16 a[142:143], v9 offset:10240
    buffer_load_dwordx4 v3, s[16:19], s60 offen offset:1024 nt lds
    v_and_b32_dpp v69, v120, v123 quad_perm:[1,1,1,1] row_mask:0xf bank_mask:0xf
    v_mul_u32_u24_dpp v70, v121, v122 quad_perm:[1,1,1,1] row_mask:0xf bank_mask:0xf
    v_and_b32_dpp v71, v121, v123 quad_perm:[1,1,1,1] row_mask:0xf bank_mask:0xf
    ds_read_b64_tr_b16 a[144:145], v6 offset:12288
    v_mul_u32_u24_dpp v72, v120, v122 quad_perm:[2,2,2,2] row_mask:0xf bank_mask:0xf
    ds_read_b64_tr_b16 a[148:149], v7 offset:12288
    s_waitcnt lgkmcnt(2)
    buffer_load_dwordx4 v4, s[16:19], s60 offen offset:2048 nt lds
    v_and_b32_dpp v73, v120, v123 quad_perm:[2,2,2,2] row_mask:0xf bank_mask:0xf
    v_mul_u32_u24_dpp v74, v121, v122 quad_perm:[2,2,2,2] row_mask:0xf bank_mask:0xf
    v_and_b32_dpp v75, v121, v123 quad_perm:[2,2,2,2] row_mask:0xf bank_mask:0xf
    ds_read_b64_tr_b16 a[152:153], v8 offset:12288
    v_mul_u32_u24_dpp v76, v120, v122 quad_perm:[3,3,3,3] row_mask:0xf bank_mask:0xf
    ds_read_b64_tr_b16 a[156:157], v9 offset:12288
    buffer_load_dwordx4 v5, s[16:19], s60 offen offset:3072 nt lds
    v_and_b32_dpp v77, v120, v123 quad_perm:[3,3,3,3] row_mask:0xf bank_mask:0xf
    s_add_u32 s60, s60, 114688
    s_cmp_eq_u32 s60, 1835008
    s_cselect_b32 s60, 0, s60
    s_add_u32 m0, s64, 12288
    v_mul_u32_u24_dpp v78, v121, v122 quad_perm:[3,3,3,3] row_mask:0xf bank_mask:0xf
    ds_read_b64_tr_b16 a[146:147], v6 offset:14336
    ds_read_b64_tr_b16 a[150:151], v7 offset:14336
    v_and_b32_dpp v79, v121, v123 quad_perm:[3,3,3,3] row_mask:0xf bank_mask:0xf
    s_waitcnt lgkmcnt(2)
    buffer_load_dwordx4 v2, s[16:19], s60 offen offset:0 nt lds
    s_xor_b32 s57, s44, 0
    s_mul_i32 s57, s57, 12288
    s_add_u32 s57, s57, 98304
    ds_read_b64_tr_b16 a[154:155], v8 offset:14336
    v_add_u32 v120, s57, v1
    ds_read_b64_tr_b16 a[158:159], v9 offset:14336
    buffer_load_dwordx4 v3, s[16:19], s60 offen offset:1024 nt lds
    s_xor_b32 s57, s44, 1
    s_mul_i32 s57, s57, 12288
    s_add_u32 s57, s57, 98304
    ds_read_b64_tr_b16 a[160:161], v6 offset:16384
    v_add_u32 v121, s57, v1
    ds_read_b64_tr_b16 a[164:165], v7 offset:16384
    s_waitcnt lgkmcnt(2)
    buffer_load_dwordx4 v4, s[16:19], s60 offen offset:2048 nt lds
    s_xor_b32 s57, s44, 2
    s_mul_i32 s57, s57, 12288
    s_add_u32 s57, s57, 98304
    ds_read_b64_tr_b16 a[168:169], v8 offset:16384
    v_add_u32 v122, s57, v1
    ds_read_b64_tr_b16 a[172:173], v9 offset:16384
    buffer_load_dwordx4 v5, s[16:19], s60 offen offset:3072 nt lds
    s_xor_b32 s57, s44, 3
    s_mul_i32 s57, s57, 12288
    s_add_u32 s57, s57, 98304
    v_add_u32 v123, s57, v1
    s_waitcnt vmcnt(8)
    v_min3_u32 v24, v24, v25, v26
    v_min3_u32 v24, v24, v27, v28
    v_min3_u32 v24, v24, v29, v30
    v_min_u32 v24, v24, v31
    v_cmp_eq_u32 vcc, 0, v24
    s_nop 4
    s_cbranch_vccnz L_spin_4
L_go_5:
    s_xor_b32 s62, s50, 1024
    buffer_load_dwordx4 v[128:131], v10, s[40:43], s62 offen sc1
    ds_read_b64_tr_b16 a[162:163], v6 offset:18432
    ds_read_b64_tr_b16 a[166:167], v7 offset:18432
    ds_read_b64_tr_b16 a[170:171], v8 offset:18432
    ds_read_b64_tr_b16 a[174:175], v9 offset:18432
    s_add_u32 s62, s62, 4096
    s_and_b32 s62, s62, 0xffff
    buffer_load_dwordx4 v[132:135], v10, s[40:43], s62 offen sc1
    ds_read_b64_tr_b16 a[176:177], v6 offset:20480
    ds_read_b64_tr_b16 a[180:181], v7 offset:20480
    ds_read_b64_tr_b16 a[184:185], v8 offset:20480
    ds_read_b64_tr_b16 a[188:189], v9 offset:20480
    s_add_u32 s62, s62, 4096
    s_and_b32 s62, s62, 0xffff
    buffer_load_dwordx4 v[136:139], v10, s[40:43], s62 offen sc1
    ds_read_b64_tr_b16 a[178:179], v6 offset:22528
    ds_read_b64_tr_b16 a[182:183], v7 offset:22528
    ds_read_b64_tr_b16 a[186:187], v8 offset:22528
    ds_read_b64_tr_b16 a[190:191], v9 offset:22528
    s_add_u32 s62, s62, 4096
    s_and_b32 s62, s62, 0xffff
    buffer_load_dwordx4 v[140:143], v10, s[40:43], s62 offen sc1
    ds_read_b64_tr_b16 a[192:193], v6 offset:0
    ds_read_b64_tr_b16 a[196:197], v7 offset:0
    ds_read_b64_tr_b16 a[200:201], v8 offset:0
    ds_read_b64_tr_b16 a[204:205], v9 offset:0
    s_add_u32 s62, s62, 4096
    s_and_b32 s62, s62, 0xffff
    buffer_load_dwordx4 v[144:147], v10, s[40:43], s62 offen sc1
    ds_read_b64_tr_b16 a[194:195], v6 offset:2048
    ds_read_b64_tr_b16 a[198:199], v7 offset:2048
    ds_read_b64_tr_b16 a[202:203], v8 offset:2048
    ds_read_b64_tr_b16 a[206:207], v9 offset:2048
    s_add_u32 s62, s62, 4096
    s_and_b32 s62, s62, 0xffff
    buffer_load_dwordx4 v[148:151], v10, s[40:43], s62 offen sc1
    ds_read_b64_tr_b16 a[208:209], v6 offset:4096
    ds_read_b64_tr_b16 a[212:213], v7 offset:4096
    ds_read_b64_tr_b16 a[216:217], v8 offset:4096
    ds_read_b64_tr_b16 a[220:221], v9 offset:4096
    s_add_u32 s62, s62, 4096
    s_and_b32 s62, s62, 0xffff
    buffer_load_dwordx4 v[152:155], v10, s[40:43], s62 offen sc1
    ds_read_b64_tr_b16 a[210:211], v6 offset:6144
    ds_read_b64_tr_b16 a[214:215], v7 offset:6144
    ds_read_b64_tr_b16 a[218:219], v8 offset:6144
    ds_read_b64_tr_b16 a[222:223], v9 offset:6144
    s_add_u32 s62, s62, 4096
    s_and_b32 s62, s62, 0xffff
    buffer_load_dwordx4 v[156:159], v10, s[40:43], s62 offen sc1
    s_waitcnt vmcnt(14)
    ds_read_b64_tr_b16 a[224:225], v6 offset:8192
    ds_read_b64_tr_b16 a[228:229], v7 offset:8192
    ds_read_b64_tr_b16 a[232:233], v8 offset:8192
    ds_read_b64_tr_b16 a[236:237], v9 offset:8192
    s_add_u32 s62, s62, 4096
    s_and_b32 s62, s62, 0xffff
    buffer_load_dwordx4 v[160:163], v10, s[40:43], s62 offen sc1
    s_waitcnt vmcnt(13)
    ds_read_b64_tr_b16 a[226:227], v6 offset:10240
    ds_read_b64_tr_b16 a[230:231], v7 offset:10240
    ds_read_b64_tr_b16 a[234:235], v8 offset:10240
    ds_read_b64_tr_b16 a[238:239], v9 offset:10240
    s_add_u32 s62, s62, 4096
    s_and_b32 s62, s62, 0xffff
    buffer_load_dwordx4 v[164:167], v10, s[40:43], s62 offen sc1
    s_waitcnt vmcnt(12)
    ds_read_b64_tr_b16 a[240:241], v6 offset:12288
    ds_read_b64_tr_b16 a[244:245], v7 offset:12288
    ds_read_b64_tr_b16 a[248:249], v8 offset:12288
    ds_read_b64_tr_b16 a[252:253], v9 offset:12288
    s_add_u32 s62, s62, 4096
    s_and_b32 s62, s62, 0xffff
    buffer_load_dwordx4 v[168:171], v10, s[40:43], s62 offen sc1
    s_waitcnt vmcnt(10)
    v_mfma_f32_16x16x32_bf16 v[80:83], a[0:3], v[128:131], 0
    ds_read_b64_tr_b16 a[242:243], v6 offset:14336
    ds_read_b64_tr_b16 a[246:247], v7 offset:14336
    v_mfma_f32_16x16x32_bf16 v[84:87], a[4:7], v[128:131], 0
    ds_read_b64_tr_b16 a[250:251], v8 offset:14336
    ds_read_b64_tr_b16 a[254:255], v9 offset:14336
    v_mfma_f32_16x16x32_bf16 v[88:91], a[8:11], v[128:131], 0
    s_add_u32 s62, s62, 4096
    s_and_b32 s62, s62, 0xffff
    v_mfma_f32_16x16x32_bf16 v[92:95], a[12:15], v[128:131], 0
    buffer_load_dwordx4 v[172:175], v10, s[40:43], s62 offen sc1
    s_waitcnt vmcnt(10)
    v_mfma_f32_16x16x32_bf16 v[80:83], a[16:19], v[132:135], v[80:83]
    s_add_u32 s62, s62, 4096
    s_and_b32 s62, s62, 0xffff
    v_mfma_f32_16x16x32_bf16 v[84:87], a[20:23], v[132:135], v[84:87]
    v_mfma_f32_16x16x32_bf16 v[88:91], a[24:27], v[132:135], v[88:91]
    v_mfma_f32_16x16x32_bf16 v[92:95], a[28:31], v[132:135], v[92:95]
    buffer_load_dwordx4 v[176:179], v10, s[40:43], s62 offen sc1
    s_waitcnt vmcnt(10)
    v_mfma_f32_16x16x32_bf16 v[80:83], a[32:35], v[136:139], v[80:83]
    s_add_u32 s62, s62, 4096
    s_and_b32 s62, s62, 0xffff
    v_mfma_f32_16x16x32_bf16 v[84:87], a[36:39], v[136:139], v[84:87]
    v_mfma_f32_16x16x32_bf16 v[88:91], a[40:43], v[136:139], v[88:91]
    v_mfma_f32_16x16x32_bf16 v[92:95], a[44:47], v[136:139], v[92:95]
    buffer_load_dwordx4 v[180:183], v10, s[40:43], s62 offen sc1
    s_waitcnt vmcnt(10)
    v_mfma_f32_16x16x32_bf16 v[80:83], a[48:51], v[140:143], v[80:83]
    s_add_u32 s62, s62, 4096
    s_and_b32 s62, s62, 0xffff
    v_mfma_f32_16x16x32_bf16 v[84:87], a[52:55], v[140:143], v[84:87]
    v_mfma_f32_16x16x32_bf16 v[88:91], a[56:59], v[140:143], v[88:91]
    v_mfma_f32_16x16x32_bf16 v[92:95], a[60:63], v[140:143], v[92:95]
    buffer_load_dwordx4 v[184:187], v10, s[40:43], s62 offen sc1
    s_waitcnt vmcnt(10)
    v_mfma_f32_16x16x32_bf16 v[80:83], a[64:67], v[144:147], v[80:83]
    s_add_u32 s62, s62, 4096
    s_and_b32 s62, s62, 0xffff
    v_mfma_f32_16x16x32_bf16 v[84:87], a[68:71], v[144:147], v[84:87]
    v_mfma_f32_16x16x32_bf16 v[88:91], a[72:75], v[144:147], v[88:91]
    v_mfma_f32_16x16x32_bf16 v[92:95], a[76:79], v[144:147], v[92:95]
    buffer_load_dwordx4 v[188:191], v10, s[40:43], s62 offen sc1
    s_waitcnt vmcnt(10)
    v_mfma_f32_16x16x32_bf16 v[80:83], a[80:83], v[148:151], v[80:83]
    s_barrier
    v_mfma_f32_16x16x32_bf16 v[84:87], a[84:87], v[148:151], v[84:87]
    v_mfma_f32_16x16x32_bf16 v[88:91], a[88:91], v[148:151], v[88:91]
    buffer_load_dword v60, v60, s[40:43], 0 offen offset:0 sc1
    s_xor_b32 s62, s50, 2048
    v_mfma_f32_16x16x32_bf16 v[92:95], a[92:95], v[148:151], v[92:95]
    s_waitcnt vmcnt(10)
    v_mfma_f32_16x16x32_bf16 v[80:83], a[96:99], v[152:155], v[80:83]
    v_mfma_f32_16x16x32_bf16 v[84:87], a[100:103], v[152:155], v[84:87]
    v_mfma_f32_16x16x32_bf16 v[88:91], a[104:107], v[152:155], v[88:91]
    buffer_load_dwordx4 v[192:195], v10, s[40:43], s62 offen sc1
    s_add_u32 s62, s62, 4096
    v_mfma_f32_16x16x32_bf16 v[92:95], a[108:111], v[152:155], v[92:95]
    s_waitcnt vmcnt(10)
    s_and_b32 s62, s62, 0xffff
    v_mfma_f32_16x16x32_bf16 v[80:83], a[112:115], v[156:159], v[80:83]
    v_mfma_f32_16x16x32_bf16 v[84:87], a[116:119], v[156:159], v[84:87]
    v_mfma_f32_16x16x32_bf16 v[88:91], a[120:123], v[156:159], v[88:91]
    buffer_load_dwordx4 v[196:199], v10, s[40:43], s62 offen sc1
    s_add_u32 s62, s62, 4096
    v_mfma_f32_16x16x32_bf16 v[92:95], a[124:127], v[156:159], v[92:95]
    s_waitcnt vmcnt(10)
    s_and_b32 s62, s62, 0xffff
    v_mfma_f32_16x16x32_bf16 v[80:83], a[128:131], v[160:163], v[80:83]
    v_mfma_f32_16x16x32_bf16 v[84:87], a[132:135], v[160:163], v[84:87]
    v_mfma_f32_16x16x32_bf16 v[88:91], a[136:139], v[160:163], v[88:91]
    buffer_load_dwordx4 v[200:203], v10, s[40:43], s62 offen sc1
    s_add_u32 s62, s62, 4096
    v_mfma_f32_16x16x32_bf16 v[92:95], a[140:143], v[160:163], v[92:95]
    s_waitcnt vmcnt(10)
    s_and_b32 s62, s62, 0xffff
    v_mfma_f32_16x16x32_bf16 v[80:83], a[144:147], v[164:167], v[80:83]
    v_mfma_f32_16x16x32_bf16 v[84:87], a[148:151], v[164:167], v[84:87]
    v_mfma_f32_16x16x32_bf16 v[88:91], a[152:155], v[164:167], v[88:91]
    buffer_load_dwordx4 v[204:207], v10, s[40:43], s62 offen sc1
    s_add_u32 s62, s62, 4096
    v_mfma_f32_16x16x32_bf16 v[92:95], a[156:159], v[164:167], v[92:95]
    s_waitcnt lgkmcnt(15)
    s_waitcnt vmcnt(10)
    v_mfma_f32_16x16x32_bf16 v[80:83], a[160:163], v[168:171], v[80:83]
    s_and_b32 s62, s62, 0xffff
    v_mfma_f32_16x16x32_bf16 v[84:87], a[164:167], v[168:171], v[84:87]
    v_mfma_f32_16x16x32_bf16 v[88:91], a[168:171], v[168:171], v[88:91]
    buffer_load_dwordx4 v[208:211], v10, s[40:43], s62 offen sc1
    s_add_u32 s62, s62, 4096
    v_mfma_f32_16x16x32_bf16 v[92:95], a[172:175], v[168:171], v[92:95]
    s_waitcnt vmcnt(10)
    s_and_b32 s62, s62, 0xffff
    v_mfma_f32_16x16x32_bf16 v[80:83], a[176:179], v[172:175], v[80:83]
    v_mfma_f32_16x16x32_bf16 v[84:87], a[180:183], v[172:175], v[84:87]
    v_mfma_f32_16x16x32_bf16 v[88:91], a[184:187], v[172:175], v[88:91]
    buffer_load_dwordx4 v[212:215], v10, s[40:43], s62 offen sc1
    s_add_u32 s62, s62, 4096
    v_mfma_f32_16x16x32_bf16 v[92:95], a[188:191], v[172:175], v[92:95]
    s_waitcnt vmcnt(10)
    s_and_b32 s62, s62, 0xffff
    v_mfma_f32_16x16x32_bf16 v[80:83], a[192:195], v[176:179], v[80:83]
    v_mfma_f32_16x16x32_bf16 v[84:87], a[196:199], v[176:179], v[84:87]
    v_mfma_f32_16x16x32_bf16 v[88:91], a[200:203], v[176:179], v[88:91]
    buffer_load_dwordx4 v[216:219], v10, s[40:43], s62 offen sc1
    s_add_u32 s62, s62, 4096
    v_mfma_f32_16x16x32_bf16 v[92:95], a[204:207], v[176:179], v[92:95]
    s_waitcnt vmcnt(10)
    s_and_b32 s62, s62, 0xffff
    v_mfma_f32_16x16x32_bf16 v[80:83], a[208:211], v[180:183], v[80:83]
    v_mfma_f32_16x16x32_bf16 v[84:87], a[212:215], v[180:183], v[84:87]
    v_mfma_f32_16x16x32_bf16 v[88:91], a[216:219], v[180:183], v[88:91]
    buffer_load_dwordx4 v[220:223], v10, s[40:43], s62 offen sc1
    s_add_u32 s62, s62, 4096
    v_mfma_f32_16x16x32_bf16 v[92:95], a[220:223], v[180:183], v[92:95]
    s_waitcnt lgkmcnt(8)
    s_waitcnt vmcnt(10)
    v_mfma_f32_16x16x32_bf16 v[80:83], a[224:227], v[184:187], v[80:83]
    s_and_b32 s62, s62, 0xffff
    v_mfma_f32_16x16x32_bf16 v[84:87], a[228:231], v[184:187], v[84:87]
    v_mfma_f32_16x16x32_bf16 v[88:91], a[232:235], v[184:187], v[88:91]
    buffer_load_dwordx4 v[224:227], v10, s[40:43], s62 offen sc1
    s_add_u32 s62, s62, 4096
    v_mfma_f32_16x16x32_bf16 v[92:95], a[236:239], v[184:187], v[92:95]
    s_waitcnt lgkmcnt(0)
    s_waitcnt vmcnt(10)
    v_mfma_f32_16x16x32_bf16 v[80:83], a[240:243], v[188:191], v[80:83]
    s_and_b32 s62, s62, 0xffff
    v_mfma_f32_16x16x32_bf16 v[84:87], a[244:247], v[188:191], v[84:87]
    v_mfma_f32_16x16x32_bf16 v[88:91], a[248:251], v[188:191], v[88:91]
    buffer_load_dwordx4 v[228:231], v10, s[40:43], s62 offen sc1
    s_add_u32 s62, s62, 4096
    v_mfma_f32_16x16x32_bf16 v[92:95], a[252:255], v[188:191], v[92:95]
    s_and_b32 s62, s62, 0xffff
    buffer_load_dwordx4 v[232:235], v10, s[40:43], s62 offen sc1
    s_waitcnt vmcnt(10)
    v_mfma_f32_16x16x32_bf16 v[96:99], a[0:3], v[192:195], 0
    s_add_u32 s62, s62, 4096
    s_and_b32 s62, s62, 0xffff
    v_mfma_f32_16x16x32_bf16 v[100:103], a[4:7], v[192:195], 0
    s_mul_i32 s64, s44, 12288
    s_add_u32 s64, s64, 102400
    v_mfma_f32_16x16x32_bf16 v[104:107], a[8:11], v[192:195], 0
    s_mul_i32 s58, s44, 1835008
    s_lshl_b32 s57, s55, 7
    v_mfma_f32_16x16x32_bf16 v[108:111], a[12:15], v[192:195], 0
    buffer_load_dwordx4 v[236:239], v10, s[40:43], s62 offen sc1
    s_waitcnt vmcnt(10)
    v_mfma_f32_16x16x32_bf16 v[96:99], a[16:19], v[196:199], v[96:99]
    ds_write_b128 v120, v[80:83] offset:4096
    v_mfma_f32_16x16x32_bf16 v[100:103], a[20:23], v[196:199], v[100:103]
    s_add_u32 s62, s62, 4096
    s_and_b32 s62, s62, 0xffff
    v_mfma_f32_16x16x32_bf16 v[104:107], a[24:27], v[196:199], v[104:107]
    buffer_load_dwordx4 v[128:131], v10, s[40:43], s62 offen sc1
    s_add_u32 s62, s62, 4096
    v_mfma_f32_16x16x32_bf16 v[108:111], a[28:31], v[196:199], v[108:111]
    s_waitcnt vmcnt(10)
    s_and_b32 s62, s62, 0xffff
    v_mfma_f32_16x16x32_bf16 v[96:99], a[32:35], v[200:203], v[96:99]
    ds_write_b128 v120, v[84:87] offset:5120
    buffer_load_dwordx4 v[132:135], v10, s[40:43], s62 offen sc1
    v_mfma_f32_16x16x32_bf16 v[100:103], a[36:39], v[200:203], v[100:103]
    s_add_u32 s62, s62, 4096
    s_and_b32 s62, s62, 0xffff
    v_mfma_f32_16x16x32_bf16 v[104:107], a[40:43], v[200:203], v[104:107]
    s_add_u32 s57, s57, s58
    v_lshrrev_b32 v16, 3, v14
    v_mfma_f32_16x16x32_bf16 v[108:111], a[44:47], v[200:203], v[108:111]
    s_waitcnt vmcnt(10)
    v_and_b32 v17, 6, v16
    v_mfma_f32_16x16x32_bf16 v[96:99], a[48:51], v[204:207], v[96:99]
    ds_write_b128 v120, v[88:91] offset:6144
    buffer_load_dwordx4 v[136:139], v10, s[40:43], s62 offen sc1
    v_mfma_f32_16x16x32_bf16 v[100:103], a[52:55], v[204:207], v[100:103]
    s_add_u32 s62, s62, 4096
    s_and_b32 s62, s62, 0xffff
    v_mfma_f32_16x16x32_bf16 v[104:107], a[56:59], v[204:207], v[104:107]
    v_and_b32 v19, 7, v14
    v_xor_b32 v17, v17, v19
    v_mfma_f32_16x16x32_bf16 v[108:111], a[60:63], v[204:207], v[108:111]
    s_waitcnt vmcnt(10)
    v_lshl_add_u32 v17, v17, 4, s57
    v_mfma_f32_16x16x32_bf16 v[96:99], a[64:67], v[208:211], v[96:99]
    ds_write_b128 v120, v[92:95] offset:7168
    buffer_load_dwordx4 v[140:143], v10, s[40:43], s62 offen sc1
    v_mfma_f32_16x16x32_bf16 v[100:103], a[68:71], v[208:211], v[100:103]
    s_xor_b32 s62, s50, 3072
    v_mul_u32_u24 v16, 4096, v16
    v_mfma_f32_16x16x32_bf16 v[104:107], a[72:75], v[208:211], v[104:107]
    v_add_u32 v2, v16, v17
    v_add_u32 v3, 31744, v2
    v_mfma_f32_16x16x32_bf16 v[108:111], a[76:79], v[208:211], v[108:111]
    s_waitcnt vmcnt(10)
    v_add_u32 v4, 63488, v2
    v_mfma_f32_16x16x32_bf16 v[96:99], a[80:83], v[212:215], v[96:99]
    buffer_load_dwordx4 v[144:147], v10, s[40:43], s62 offen sc1
    s_add_u32 s62, s62, 4096
    v_mfma_f32_16x16x32_bf16 v[100:103], a[84:87], v[212:215], v[100:103]
    s_and_b32 s62, s62, 0xffff
    v_add_u32 v5, 95232, v2
    v_mfma_f32_16x16x32_bf16 v[104:107], a[88:91], v[212:215], v[104:107]
    v_lshrrev_b32 v16, 2, v14
    v_bfe_u32 v17, v14, 3, 2
    v_mfma_f32_16x16x32_bf16 v[108:111], a[92:95], v[212:215], v[108:111]
    s_waitcnt vmcnt(10)
    v_xor_b32 v17, s44, v17
    v_mfma_f32_16x16x32_bf16 v[96:99], a[96:99], v[216:219], v[96:99]
    buffer_load_dwordx4 v[148:151], v10, s[40:43], s62 offen sc1
    s_add_u32 s62, s62, 4096
    v_mfma_f32_16x16x32_bf16 v[100:103], a[100:103], v[216:219], v[100:103]
    s_and_b32 s62, s62, 0xffff
    v_lshlrev_b32 v16, 7, v16
    v_mfma_f32_16x16x32_bf16 v[104:107], a[104:107], v[216:219], v[104:107]
    v_and_b32 v19, 3, v14
    v_lshl_add_u32 v16, v19, 3, v16
    v_mfma_f32_16x16x32_bf16 v[108:111], a[108:111], v[216:219], v[108:111]
    s_waitcnt vmcnt(10)
    v_add_u32 v16, s64, v16
    v_mfma_f32_16x16x32_bf16 v[96:99], a[112:115], v[220:223], v[96:99]
    buffer_load_dwordx4 v[152:155], v10, s[40:43], s62 offen sc1
    s_add_u32 s62, s62, 4096
    v_mfma_f32_16x16x32_bf16 v[100:103], a[116:119], v[220:223], v[100:103]
    s_and_b32 s62, s62, 0xffff
    v_xor_b32 v19, 0, v17
    v_mfma_f32_16x16x32_bf16 v[104:107], a[120:123], v[220:223], v[104:107]
    v_lshl_add_u32 v6, v19, 5, v16
    v_xor_b32 v19, 1, v17
    v_mfma_f32_16x16x32_bf16 v[108:111], a[124:127], v[220:223], v[108:111]
    s_waitcnt vmcnt(10)
    v_lshl_add_u32 v7, v19, 5, v16
    v_mfma_f32_16x16x32_bf16 v[96:99], a[128:131], v[224:227], v[96:99]
    buffer_load_dwordx4 v[156:159], v10, s[40:43], s62 offen sc1
    s_add_u32 s62, s62, 4096
    v_mfma_f32_16x16x32_bf16 v[100:103], a[132:135], v[224:227], v[100:103]
    s_and_b32 s62, s62, 0xffff
    v_xor_b32 v19, 2, v17
    v_mfma_f32_16x16x32_bf16 v[104:107], a[136:139], v[224:227], v[104:107]
    v_lshl_add_u32 v8, v19, 5, v16
    v_xor_b32 v19, 3, v17
    v_mfma_f32_16x16x32_bf16 v[108:111], a[140:143], v[224:227], v[108:111]
    s_waitcnt vmcnt(10)
    v_lshl_add_u32 v9, v19, 5, v16
    v_mfma_f32_16x16x32_bf16 v[96:99], a[144:147], v[228:231], v[96:99]
    buffer_load_dwordx4 v[160:163], v10, s[40:43], s62 offen sc1
    s_add_u32 s62, s62, 4096
    v_mfma_f32_16x16x32_bf16 v[100:103], a[148:151], v[228:231], v[100:103]
    s_and_b32 s62, s62, 0xffff
    v_lshrrev_b32 v16, 1, v14
    v_mfma_f32_16x16x32_bf16 v[104:107], a[152:155], v[228:231], v[104:107]
    v_min_u32 v16, 6, v16
    s_mul_i32 s57, s44, 7
    v_mfma_f32_16x16x32_bf16 v[108:111], a[156:159], v[228:231], v[108:111]
    s_waitcnt vmcnt(10)
    v_add_u32 v16, s57, v16
    v_mfma_f32_16x16x32_bf16 v[96:99], a[160:163], v[232:235], v[96:99]
    buffer_load_dwordx4 v[164:167], v10, s[40:43], s62 offen sc1
    s_add_u32 s62, s62, 4096
    v_mfma_f32_16x16x32_bf16 v[100:103], a[164:167], v[232:235], v[100:103]
    s_and_b32 s62, s62, 0xffff
    v_mul_u32_u24 v16, 7, v16
    v_mfma_f32_16x16x32_bf16 v[104:107], a[168:171], v[232:235], v[104:107]
    v_add_u32 v16, s54, v16
    v_mul_u32_u24 v17, 2675, v16
    v_mfma_f32_16x16x32_bf16 v[108:111], a[172:175], v[232:235], v[108:111]
    s_waitcnt vmcnt(10)
    v_lshrrev_b32 v17, 16, v17
    v_mfma_f32_16x16x32_bf16 v[96:99], a[176:179], v[236:239], v[96:99]
    buffer_load_dwordx4 v[168:171], v10, s[40:43], s62 offen sc1
    s_add_u32 s62, s62, 4096
    v_mfma_f32_16x16x32_bf16 v[100:103], a[180:183], v[236:239], v[100:103]
    s_and_b32 s62, s62, 0xffff
    v_mul_u32_u24 v18, 49, v17
    v_mfma_f32_16x16x32_bf16 v[104:107], a[184:187], v[236:239], v[104:107]
    v_add_u32 v18, 1, v18
    v_lshrrev_b32 v18, 1, v18
    v_mfma_f32_16x16x32_bf16 v[108:111], a[188:191], v[236:239], v[108:111]
    s_waitcnt vmcnt(10)
    v_sub_u32 v16, v16, v18
    v_mfma_f32_16x16x32_bf16 v[96:99], a[192:195], v[128:131], v[96:99]
    buffer_load_dwordx4 v[172:175], v10, s[40:43], s62 offen sc1
    s_add_u32 s62, s62, 4096
    v_mfma_f32_16x16x32_bf16 v[100:103], a[196:199], v[128:131], v[100:103]
    s_and_b32 s62, s62, 0xffff
    v_lshl_add_u32 v16, v16, 3, v17
    v_mfma_f32_16x16x32_bf16 v[104:107], a[200:203], v[128:131], v[104:107]
    v_lshlrev_b32 v16, 8, v16
    v_and_b32 v17, 1, v14
    v_mfma_f32_16x16x32_bf16 v[108:111], a[204:207], v[128:131], v[108:111]
    s_waitcnt vmcnt(10)
    v_lshl_add_u32 v16, v17, 3, v16
    v_mfma_f32_16x16x32_bf16 v[96:99], a[208:211], v[132:135], v[96:99]
    buffer_load_dwordx4 v[176:179], v10, s[40:43], s62 offen sc1
    s_add_u32 s62, s62, 4096
    v_mfma_f32_16x16x32_bf16 v[100:103], a[212:215], v[132:135], v[100:103]
    s_and_b32 s62, s62, 0xffff
    v_add_u32 v62, 65536, v16
    v_mfma_f32_16x16x32_bf16 v[104:107], a[216:219], v[132:135], v[104:107]
    s_mov_b32 s76, 0xbdd2d3e8
    v_mov_b32 v124, 0xc0135761
    v_mfma_f32_16x16x32_bf16 v[108:111], a[220:223], v[132:135], v[108:111]
    s_waitcnt vmcnt(10)
    v_mov_b32 v125, 0xc0135761
    v_mfma_f32_16x16x32_bf16 v[96:99], a[224:227], v[136:139], v[96:99]
    buffer_load_dwordx4 v[180:183], v10, s[40:43], s62 offen sc1
    s_add_u32 s62, s62, 4096
    v_mfma_f32_16x16x32_bf16 v[100:103], a[228:231], v[136:139], v[100:103]
    s_and_b32 s62, s62, 0xffff
    s_mul_i32 s57, s49, 229376
    v_mfma_f32_16x16x32_bf16 v[104:107], a[232:235], v[136:139], v[104:107]
    s_lshl_b32 s58, s48, 11
    s_add_u32 s57, s57, s58
    v_mfma_f32_16x16x32_bf16 v[108:111], a[236:239], v[136:139], v[108:111]
    s_waitcnt vmcnt(10)
    s_mul_i32 s58, s44, 57344
    v_mfma_f32_16x16x32_bf16 v[96:99], a[240:243], v[140:143], v[96:99]
    buffer_load_dwordx4 v[184:187], v10, s[40:43], s62 offen sc1
    s_add_u32 s62, s62, 4096
    v_mfma_f32_16x16x32_bf16 v[100:103], a[244:247], v[140:143], v[100:103]
    s_and_b32 s62, s62, 0xffff
    s_add_u32 s57, s57, s58
    v_mfma_f32_16x16x32_bf16 v[104:107], a[248:251], v[140:143], v[104:107]
    s_add_u32 s36, s57, 7340032
    v_mfma_f32_16x16x32_bf16 v[108:111], a[252:255], v[140:143], v[108:111]
    s_waitcnt lgkmcnt(0)
    s_waitcnt vmcnt(10)
    v_mfma_f32_16x16x32_bf16 v[80:83], a[0:3], v[144:147], 0
    buffer_load_dwordx4 v[188:191], v10, s[40:43], s62 offen sc1
    s_add_u32 s62, s62, 4096
    v_mfma_f32_16x16x32_bf16 v[84:87], a[4:7], v[144:147], 0
    s_and_b32 s62, s62, 0xffff
    v_mfma_f32_16x16x32_bf16 v[88:91], a[8:11], v[144:147], 0
    v_mfma_f32_16x16x32_bf16 v[92:95], a[12:15], v[144:147], 0
    s_waitcnt vmcnt(10)
    v_mfma_f32_16x16x32_bf16 v[80:83], a[16:19], v[148:151], v[80:83]
    ds_write_b128 v120, v[96:99] offset:8192
    buffer_load_dwordx4 v[192:195], v10, s[40:43], s62 offen sc1
    v_mfma_f32_16x16x32_bf16 v[84:87], a[20:23], v[148:151], v[84:87]
    s_add_u32 s62, s62, 4096
    s_and_b32 s62, s62, 0xffff
    v_mfma_f32_16x16x32_bf16 v[88:91], a[24:27], v[148:151], v[88:91]
    v_mfma_f32_16x16x32_bf16 v[92:95], a[28:31], v[148:151], v[92:95]
    s_waitcnt vmcnt(10)
    v_mfma_f32_16x16x32_bf16 v[80:83], a[32:35], v[152:155], v[80:83]
    ds_write_b128 v120, v[100:103] offset:9216
    buffer_load_dwordx4 v[196:199], v10, s[40:43], s62 offen sc1
    v_mfma_f32_16x16x32_bf16 v[84:87], a[36:39], v[152:155], v[84:87]
    s_add_u32 s62, s62, 4096
    s_and_b32 s62, s62, 0xffff
    v_mfma_f32_16x16x32_bf16 v[88:91], a[40:43], v[152:155], v[88:91]
    v_mfma_f32_16x16x32_bf16 v[92:95], a[44:47], v[152:155], v[92:95]
    s_waitcnt vmcnt(10)
    v_mfma_f32_16x16x32_bf16 v[80:83], a[48:51], v[156:159], v[80:83]
    ds_write_b128 v120, v[104:107] offset:10240
    buffer_load_dwordx4 v[200:203], v10, s[40:43], s62 offen sc1
    v_mfma_f32_16x16x32_bf16 v[84:87], a[52:55], v[156:159], v[84:87]
    s_add_u32 s62, s62, 4096
    s_and_b32 s62, s62, 0xffff
    v_mfma_f32_16x16x32_bf16 v[88:91], a[56:59], v[156:159], v[88:91]
    v_mfma_f32_16x16x32_bf16 v[92:95], a[60:63], v[156:159], v[92:95]
    s_waitcnt vmcnt(10)
    v_mfma_f32_16x16x32_bf16 v[80:83], a[64:67], v[160:163], v[80:83]
    ds_write_b128 v120, v[108:111] offset:11264
    buffer_load_dwordx4 v[204:207], v10, s[40:43], s62 offen sc1
    v_mfma_f32_16x16x32_bf16 v[84:87], a[68:71], v[160:163], v[84:87]
    s_xor_b32 s62, s50, 0
    v_mfma_f32_16x16x32_bf16 v[88:91], a[72:75], v[160:163], v[88:91]
    v_mfma_f32_16x16x32_bf16 v[92:95], a[76:79], v[160:163], v[92:95]
    s_waitcnt vmcnt(10)
    v_mfma_f32_16x16x32_bf16 v[80:83], a[80:83], v[164:167], v[80:83]
    buffer_load_dwordx4 v[208:211], v10, s[40:43], s62 offen sc1
    s_add_u32 s62, s62, 4096
    v_mfma_f32_16x16x32_bf16 v[84:87], a[84:87], v[164:167], v[84:87]
    s_and_b32 s62, s62, 0xffff
    v_mfma_f32_16x16x32_bf16 v[88:91], a[88:91], v[164:167], v[88:91]
    v_mfma_f32_16x16x32_bf16 v[92:95], a[92:95], v[164:167], v[92:95]
    s_waitcnt vmcnt(10)
    ds_bpermute_b32 v44, v53, v60 offset:64
    v_mfma_f32_16x16x32_bf16 v[80:83], a[96:99], v[168:171], v[80:83]
    buffer_load_dwordx4 v[212:215], v10, s[40:43], s62 offen sc1
    s_add_u32 s62, s62, 4096
    v_mfma_f32_16x16x32_bf16 v[84:87], a[100:103], v[168:171], v[84:87]
    s_and_b32 s62, s62, 0xffff
    ds_bpermute_b32 v45, v53, v60 offset:128
    v_mfma_f32_16x16x32_bf16 v[88:91], a[104:107], v[168:171], v[88:91]
    ds_bpermute_b32 v252, v54, v60
    ds_bpermute_b32 v253, v55, v60 offset:8
    v_mfma_f32_16x16x32_bf16 v[92:95], a[108:111], v[168:171], v[92:95]
    s_waitcnt vmcnt(10)
    ds_bpermute_b32 v254, v54, v60 offset:64
    v_mfma_f32_16x16x32_bf16 v[80:83], a[112:115], v[172:175], v[80:83]
    buffer_load_dwordx4 v[216:219], v10, s[40:43], s62 offen sc1
    s_add_u32 s62, s62, 4096
    v_mfma_f32_16x16x32_bf16 v[84:87], a[116:119], v[172:175], v[84:87]
    s_and_b32 s62, s62, 0xffff
    ds_bpermute_b32 v255, v55, v60 offset:72
    v_mfma_f32_16x16x32_bf16 v[88:91], a[120:123], v[172:175], v[88:91]
    v_mfma_f32_16x16x32_bf16 v[92:95], a[124:127], v[172:175], v[92:95]
    s_waitcnt vmcnt(10)
    v_mfma_f32_16x16x32_bf16 v[80:83], a[128:131], v[176:179], v[80:83]
    buffer_load_dwordx4 v[220:223], v10, s[40:43], s62 offen sc1
    s_add_u32 s62, s62, 4096
    v_mfma_f32_16x16x32_bf16 v[84:87], a[132:135], v[176:179], v[84:87]
    s_and_b32 s62, s62, 0xffff
    v_mfma_f32_16x16x32_bf16 v[88:91], a[136:139], v[176:179], v[88:91]
    v_mfma_f32_16x16x32_bf16 v[92:95], a[140:143], v[176:179], v[92:95]
    s_waitcnt vmcnt(10)
    v_mfma_f32_16x16x32_bf16 v[80:83], a[144:147], v[180:183], v[80:83]
    buffer_load_dwordx4 v[224:227], v10, s[40:43], s62 offen sc1
    v_mfma_f32_16x16x32_bf16 v[84:87], a[148:151], v[180:183], v[84:87]
    v_mfma_f32_16x16x32_bf16 v[88:91], a[152:155], v[180:183], v[88:91]
    v_mfma_f32_16x16x32_bf16 v[92:95], a[156:159], v[180:183], v[92:95]
    s_waitcnt vmcnt(10)
    v_mfma_f32_16x16x32_bf16 v[80:83], a[160:163], v[184:187], v[80:83]
    buffer_load_dword v40, v63, s[40:43], 0 offen sc1
    s_add_u32 s62, s62, 4096
    v_mfma_f32_16x16x32_bf16 v[84:87], a[164:167], v[184:187], v[84:87]
    s_and_b32 s62, s62, 0xffff
    v_mfma_f32_16x16x32_bf16 v[88:91], a[168:171], v[184:187], v[88:91]
    v_mfma_f32_16x16x32_bf16 v[92:95], a[172:175], v[184:187], v[92:95]
    s_waitcnt vmcnt(10)
    v_mfma_f32_16x16x32_bf16 v[80:83], a[176:179], v[188:191], v[80:83]
    buffer_load_dwordx4 v[228:231], v10, s[40:43], s62 offen sc1
    s_add_u32 s62, s62, 4096
    v_mfma_f32_16x16x32_bf16 v[84:87], a[180:183], v[188:191], v[84:87]
    s_and_b32 s62, s62, 0xffff
    v_mfma_f32_16x16x32_bf16 v[88:91], a[184:187], v[188:191], v[88:91]
    v_mfma_f32_16x16x32_bf16 v[92:95], a[188:191], v[188:191], v[92:95]
    s_waitcnt vmcnt(10)
    s_waitcnt lgkmcnt(0)
    v_mfma_f32_16x16x32_bf16 v[80:83], a[192:195], v[192:195], v[80:83]
    buffer_load_dwordx4 v[232:235], v10, s[40:43], s62 offen sc1
    s_add_u32 s62, s62, 4096
    v_mfma_f32_16x16x32_bf16 v[84:87], a[196:199], v[192:195], v[84:87]
    s_and_b32 s62, s62, 0xffff
    v_mul_f32 v44, 0x3e8b97f6, v44
    v_mfma_f32_16x16x32_bf16 v[88:91], a[200:203], v[192:195], v[88:91]
    v_mul_f32 v45, 0x3e8b97f6, v45
    v_mul_f32 v248, v44, v252
    v_mfma_f32_16x16x32_bf16 v[92:95], a[204:207], v[192:195], v[92:95]
    s_waitcnt vmcnt(10)
    v_mul_f32 v249, v44, v253
    v_mfma_f32_16x16x32_bf16 v[80:83], a[208:211], v[196:199], v[80:83]
    buffer_load_dwordx4 v[236:239], v10, s[40:43], s62 offen sc1
    s_add_u32 s62, s62, 4096
    v_mfma_f32_16x16x32_bf16 v[84:87], a[212:215], v[196:199], v[84:87]
    s_and_b32 s62, s62, 0xffff
    v_mul_f32 v250, v45, v254
    v_mfma_f32_16x16x32_bf16 v[88:91], a[216:219], v[196:199], v[88:91]
    v_mul_f32 v251, v45, v255
    v_add_u32 v60, 48384, v56
    v_mfma_f32_16x16x32_bf16 v[92:95], a[220:223], v[196:199], v[92:95]
    s_waitcnt vmcnt(10)
    v_cndmask_b32 v53, v1, v59, s[78:79]
    v_mfma_f32_16x16x32_bf16 v[80:83], a[224:227], v[200:203], v[80:83]
    buffer_load_dwordx4 v[128:131], v10, s[40:43], s62 offen sc1
    s_add_u32 s62, s62, 4096
    v_mfma_f32_16x16x32_bf16 v[84:87], a[228:231], v[200:203], v[84:87]
    s_and_b32 s62, s62, 0xffff
    v_subrev_u32 v54, 48, v14
    v_mfma_f32_16x16x32_bf16 v[88:91], a[232:235], v[200:203], v[88:91]
    v_ashrrev_i32 v54, 31, v54
    v_mfma_f32_16x16x32_bf16 v[92:95], a[236:239], v[200:203], v[92:95]
    s_waitcnt vmcnt(10)
    v_mfma_f32_16x16x32_bf16 v[80:83], a[240:243], v[204:207], v[80:83]
    buffer_load_dwordx4 v[132:135], v10, s[40:43], s62 offen sc1
    s_add_u32 s62, s62, 4096
    v_mfma_f32_16x16x32_bf16 v[84:87], a[244:247], v[204:207], v[84:87]
    s_and_b32 s62, s62, 0xffff
    v_mfma_f32_16x16x32_bf16 v[88:91], a[248:251], v[204:207], v[88:91]
    v_mfma_f32_16x16x32_bf16 v[92:95], a[252:255], v[204:207], v[92:95]
    s_waitcnt vmcnt(10)
    v_mfma_f32_16x16x32_bf16 v[64:67], a[0:3], v[208:211], v[64:67]
    buffer_load_dwordx4 v[136:139], v10, s[40:43], s62 offen sc1
    s_add_u32 s62, s62, 4096
    v_mfma_f32_16x16x32_bf16 v[68:71], a[4:7], v[208:211], v[68:71]
    s_and_b32 s62, s62, 0xffff
    v_mfma_f32_16x16x32_bf16 v[72:75], a[8:11], v[208:211], v[72:75]
    v_mfma_f32_16x16x32_bf16 v[76:79], a[12:15], v[208:211], v[76:79]
    s_waitcnt vmcnt(10)
    v_mfma_f32_16x16x32_bf16 v[64:67], a[16:19], v[212:215], v[64:67]
    ds_write_b128 v120, v[80:83] offset:12288
    buffer_load_dwordx4 v[140:143], v10, s[40:43], s62 offen sc1
    v_mfma_f32_16x16x32_bf16 v[68:71], a[20:23], v[212:215], v[68:71]
    s_add_u32 s62, s62, 4096
    s_and_b32 s62, s62, 0xffff
    v_mfma_f32_16x16x32_bf16 v[72:75], a[24:27], v[212:215], v[72:75]
    v_mfma_f32_16x16x32_bf16 v[76:79], a[28:31], v[212:215], v[76:79]
    s_waitcnt vmcnt(10)
    v_mfma_f32_16x16x32_bf16 v[64:67], a[32:35], v[216:219], v[64:67]
    ds_write_b128 v120, v[84:87] offset:13312
    buffer_load_dwordx4 v[144:147], v10, s[40:43], s62 offen sc1
    v_mfma_f32_16x16x32_bf16 v[68:71], a[36:39], v[216:219], v[68:71]
    s_add_u32 s62, s62, 4096
    s_and_b32 s62, s62, 0xffff
    v_mfma_f32_16x16x32_bf16 v[72:75], a[40:43], v[216:219], v[72:75]
    v_mfma_f32_16x16x32_bf16 v[76:79], a[44:47], v[216:219], v[76:79]
    s_waitcnt vmcnt(10)
    v_mfma_f32_16x16x32_bf16 v[64:67], a[48:51], v[220:223], v[64:67]
    ds_write_b128 v120, v[88:91] offset:14336
    buffer_load_dwordx4 v[148:151], v10, s[40:43], s62 offen sc1
    v_mfma_f32_16x16x32_bf16 v[68:71], a[52:55], v[220:223], v[68:71]
    s_add_u32 s62, s62, 4096
    s_and_b32 s62, s62, 0xffff
    v_mfma_f32_16x16x32_bf16 v[72:75], a[56:59], v[220:223], v[72:75]
    v_mfma_f32_16x16x32_bf16 v[76:79], a[60:63], v[220:223], v[76:79]
    s_waitcnt vmcnt(10)
    v_mfma_f32_16x16x32_bf16 v[64:67], a[64:67], v[224:227], v[64:67]
    ds_write_b128 v120, v[92:95] offset:15360
    buffer_load_dwordx4 v[152:155], v10, s[40:43], s62 offen sc1
    v_mfma_f32_16x16x32_bf16 v[68:71], a[68:71], v[224:227], v[68:71]
    s_add_u32 s62, s62, 4096
    s_and_b32 s62, s62, 0xffff
    v_mfma_f32_16x16x32_bf16 v[72:75], a[72:75], v[224:227], v[72:75]
    v_mfma_f32_16x16x32_bf16 v[76:79], a[76:79], v[224:227], v[76:79]
    buffer_load_dwordx4 v[156:159], v10, s[40:43], s62 offen sc1
    s_waitcnt vmcnt(10)
    v_mfma_f32_16x16x32_bf16 v[64:67], a[80:83], v[228:231], v[64:67]
    v_or_b32 v40, s44, v40
    v_cmp_eq_u32 vcc, 0, v40
    s_nop 4
    s_cbranch_vccnz L_spin_8
L_go_9:
    s_waitcnt lgkmcnt(0)
    s_barrier
    v_mfma_f32_16x16x32_bf16 v[68:71], a[84:87], v[228:231], v[68:71]
    s_add_u32 m0, s9, 0
    s_add_u32 s60, s69, 0
    v_mfma_f32_16x16x32_bf16 v[72:75], a[88:91], v[228:231], v[72:75]
    buffer_load_dwordx4 v59, s[40:43], s60 offen offset:0 sc1 lds
    ds_read_b128 v[16:19], v121 offset:4096
    v_mfma_f32_16x16x32_bf16 v[76:79], a[92:95], v[228:231], v[76:79]
    s_waitcnt vmcnt(10)
    s_add_u32 m0, s9, 4096
    v_mfma_f32_16x16x32_bf16 v[64:67], a[96:99], v[232:235], v[64:67]
    ds_read_b128 v[96:99], v122 offset:8192
    s_add_u32 s60, s69, 524288
    v_mfma_f32_16x16x32_bf16 v[68:71], a[100:103], v[232:235], v[68:71]
    buffer_load_dwordx4 v59, s[40:43], s60 offen offset:0 sc1 lds
    s_add_u32 m0, s9, 8192
    v_mfma_f32_16x16x32_bf16 v[72:75], a[104:107], v[232:235], v[72:75]
    ds_read_b128 v[80:83], v123 offset:12288
    s_add_u32 s60, s69, 1048576
    v_mfma_f32_16x16x32_bf16 v[76:79], a[108:111], v[232:235], v[76:79]
    s_waitcnt vmcnt(10)
    v_mfma_f32_16x16x32_bf16 v[64:67], a[112:115], v[236:239], v[64:67]
    ds_read_b128 v[20:23], v121 offset:5120
    buffer_load_dwordx4 v59, s[40:43], s60 offen offset:0 sc1 lds
    v_mfma_f32_16x16x32_bf16 v[68:71], a[116:119], v[236:239], v[68:71]
    s_mov_b32 m0, s10
    s_mov_b32 s60, s11
    v_mfma_f32_16x16x32_bf16 v[72:75], a[120:123], v[236:239], v[72:75]
    ds_read_b128 v[100:103], v122 offset:9216
    v_mfma_f32_16x16x32_bf16 v[76:79], a[124:127], v[236:239], v[76:79]
    s_waitcnt vmcnt(10)
    buffer_load_dwordx4 v53, s[40:43], s60 offen offset:0 sc1 lds
    v_mfma_f32_16x16x32_bf16 v[64:67], a[128:131], v[128:131], v[64:67]
    ds_read_b128 v[84:87], v123 offset:13312
    s_add_u32 m0, s8, 0
    v_mfma_f32_16x16x32_bf16 v[68:71], a[132:135], v[128:131], v[68:71]
    s_add_u32 s60, s67, 0
    v_mfma_f32_16x16x32_bf16 v[72:75], a[136:139], v[128:131], v[72:75]
    ds_read_b128 v[24:27], v121 offset:6144
    buffer_load_dwordx4 v1, s[40:43], s60 offen offset:0 sc1 lds
    v_mfma_f32_16x16x32_bf16 v[76:79], a[140:143], v[128:131], v[76:79]
    s_waitcnt vmcnt(11)
    v_mfma_f32_16x16x32_bf16 v[64:67], a[144:147], v[132:135], v[64:67]
    ds_read_b128 v[104:107], v122 offset:10240
    v_mfma_f32_16x16x32_bf16 v[68:71], a[148:151], v[132:135], v[68:71]
    buffer_load_dwordx4 v1, s[40:43], s60 offen offset:1024 sc1 lds
    v_mfma_f32_16x16x32_bf16 v[72:75], a[152:155], v[132:135], v[72:75]
    ds_read_b128 v[88:91], v123 offset:14336
    v_mfma_f32_16x16x32_bf16 v[76:79], a[156:159], v[132:135], v[76:79]
    s_waitcnt vmcnt(11)
    v_mfma_f32_16x16x32_bf16 v[64:67], a[160:163], v[136:139], v[64:67]
    ds_read_b128 v[28:31], v121 offset:7168
    buffer_load_dwordx4 v1, s[40:43], s60 offen offset:2048 sc1 lds
    v_mfma_f32_16x16x32_bf16 v[68:71], a[164:167], v[136:139], v[68:71]
    v_mfma_f32_16x16x32_bf16 v[72:75], a[168:171], v[136:139], v[72:75]
    ds_read_b128 v[108:111], v122 offset:11264
    v_mfma_f32_16x16x32_bf16 v[76:79], a[172:175], v[136:139], v[76:79]
    s_waitcnt vmcnt(11)
    buffer_load_dwordx4 v1, s[40:43], s60 offen offset:3072 sc1 lds
    v_mfma_f32_16x16x32_bf16 v[64:67], a[176:179], v[140:143], v[64:67]
    ds_read_b128 v[92:95], v123 offset:15360
    s_add_u32 m0, s8, 4096
    v_mfma_f32_16x16x32_bf16 v[68:71], a[180:183], v[140:143], v[68:71]
    s_add_u32 s60, s67, 4096
    v_mfma_f32_16x16x32_bf16 v[72:75], a[184:187], v[140:143], v[72:75]
    buffer_load_dwordx4 v1, s[40:43], s60 offen offset:0 sc1 lds
    v_mfma_f32_16x16x32_bf16 v[76:79], a[188:191], v[140:143], v[76:79]
    s_waitcnt vmcnt(12)
    v_mfma_f32_16x16x32_bf16 v[64:67], a[192:195], v[144:147], v[64:67]
    v_mfma_f32_16x16x32_bf16 v[68:71], a[196:199], v[144:147], v[68:71]
    buffer_load_dwordx4 v1, s[40:43], s60 offen offset:1024 sc1 lds
    v_mfma_f32_16x16x32_bf16 v[72:75], a[200:203], v[144:147], v[72:75]
    v_mfma_f32_16x16x32_bf16 v[76:79], a[204:207], v[144:147], v[76:79]
    s_waitcnt vmcnt(12)
    v_mfma_f32_16x16x32_bf16 v[64:67], a[208:211], v[148:151], v[64:67]
    buffer_load_dwordx4 v1, s[40:43], s60 offen offset:2048 sc1 lds
    v_mfma_f32_16x16x32_bf16 v[68:71], a[212:215], v[148:151], v[68:71]
    v_mfma_f32_16x16x32_bf16 v[72:75], a[216:219], v[148:151], v[72:75]
    v_mfma_f32_16x16x32_bf16 v[76:79], a[220:223], v[148:151], v[76:79]
    s_waitcnt vmcnt(12)
    buffer_load_dwordx4 v1, s[40:43], s60 offen offset:3072 sc1 lds
    v_mfma_f32_16x16x32_bf16 v[64:67], a[224:227], v[152:155], v[64:67]
    s_add_u32 m0, s8, 8192
    s_add_u32 s60, s67, 8192
    v_mfma_f32_16x16x32_bf16 v[68:71], a[228:231], v[152:155], v[68:71]
    v_mfma_f32_16x16x32_bf16 v[72:75], a[232:235], v[152:155], v[72:75]
    buffer_load_dwordx4 v1, s[40:43], s60 offen offset:0 sc1 lds
    v_mfma_f32_16x16x32_bf16 v[76:79], a[236:239], v[152:155], v[76:79]
    s_waitcnt vmcnt(13)
    v_mfma_f32_16x16x32_bf16 v[64:67], a[240:243], v[156:159], v[64:67]
    v_mfma_f32_16x16x32_bf16 v[68:71], a[244:247], v[156:159], v[68:71]
    buffer_load_dwordx4 v1, s[40:43], s60 offen offset:1024 sc1 lds
    v_mfma_f32_16x16x32_bf16 v[72:75], a[248:251], v[156:159], v[72:75]
    v_mfma_f32_16x16x32_bf16 v[76:79], a[252:255], v[156:159], v[76:79]
    s_waitcnt lgkmcnt(0)
    s_barrier
    buffer_load_dwordx4 v1, s[40:43], s60 offen offset:2048 sc1 lds
    v_pk_add_f32 v[96:97], v[96:97], v[16:17]
    v_pk_add_f32 v[98:99], v[98:99], v[18:19]
    v_pk_add_f32 v[100:101], v[100:101], v[20:21]
    v_pk_add_f32 v[102:103], v[102:103], v[22:23]
    v_pk_add_f32 v[104:105], v[104:105], v[24:25]
    v_pk_add_f32 v[106:107], v[106:107], v[26:27]
    v_pk_add_f32 v[108:109], v[108:109], v[28:29]
    v_pk_add_f32 v[110:111], v[110:111], v[30:31]
    v_pk_add_f32 v[64:65], v[64:65], v[80:81]
    v_pk_add_f32 v[66:67], v[66:67], v[82:83]
    v_pk_add_f32 v[68:69], v[68:69], v[84:85]
    buffer_load_dwordx4 v1, s[40:43], s60 offen offset:3072 sc1 lds
    v_pk_add_f32 v[70:71], v[70:71], v[86:87]
    v_pk_add_f32 v[72:73], v[72:73], v[88:89]
    v_pk_add_f32 v[74:75], v[74:75], v[90:91]
    v_pk_add_f32 v[76:77], v[76:77], v[92:93]
    v_pk_add_f32 v[78:79], v[78:79], v[94:95]
    v_pk_add_f32 v[64:65], v[64:65], v[96:97]
    v_pk_add_f32 v[66:67], v[66:67], v[98:99]
    v_pk_add_f32 v[68:69], v[68:69], v[100:101]
    s_add_u32 m0, s8, 12288
    v_pk_add_f32 v[70:71], v[70:71], v[102:103]
    s_add_u32 s60, s67, 12288
    buffer_load_dwordx4 v1, s[40:43], s60 offen offset:0 sc1 lds
    v_pk_add_f32 v[72:73], v[72:73], v[104:105]
    v_pk_add_f32 v[74:75], v[74:75], v[106:107]
    v_pk_add_f32 v[76:77], v[76:77], v[108:109]
    v_pk_add_f32 v[78:79], v[78:79], v[110:111]
    v_pk_mul_f32 v[80:81], v[64:65], v[64:65]
    v_pk_fma_f32 v[80:81], v[80:81], s[76:77], v[124:125] op_sel_hi:[1,0,1]
    v_pk_mul_f32 v[80:81], v[80:81], v[64:65]
    v_pk_mul_f32 v[82:83], v[66:67], v[66:67]
    v_pk_fma_f32 v[82:83], v[82:83], s[76:77], v[124:125] op_sel_hi:[1,0,1]
    v_pk_mul_f32 v[82:83], v[82:83], v[66:67]
    v_exp_f32 v80, v80
    buffer_load_dwordx4 v1, s[40:43], s60 offen offset:1024 sc1 lds
    v_exp_f32 v81, v81
    v_exp_f32 v82, v82
    v_exp_f32 v83, v83
    v_pk_add_f32 v[80:81], v[80:81], 1.0 op_sel_hi:[1,0]
    v_pk_add_f32 v[82:83], v[82:83], 1.0 op_sel_hi:[1,0]
    v_rcp_f32 v80, v80
    v_rcp_f32 v81, v81
    buffer_load_dwordx4 v1, s[40:43], s60 offen offset:2048 sc1 lds
    v_rcp_f32 v82, v82
    v_rcp_f32 v83, v83
    v_pk_mul_f32 v[64:65], v[64:65], v[80:81]
    v_pk_mul_f32 v[66:67], v[66:67], v[82:83]
    v_pk_mul_f32 v[84:85], v[68:69], v[68:69]
    v_pk_fma_f32 v[84:85], v[84:85], s[76:77], v[124:125] op_sel_hi:[1,0,1]
    v_pk_mul_f32 v[84:85], v[84:85], v[68:69]
    v_pk_mul_f32 v[86:87], v[70:71], v[70:71]
    v_pk_fma_f32 v[86:87], v[86:87], s[76:77], v[124:125] op_sel_hi:[1,0,1]
    buffer_load_dwordx4 v1, s[40:43], s60 offen offset:3072 sc1 lds
    v_pk_mul_f32 v[86:87], v[86:87], v[70:71]
    v_exp_f32 v84, v84
    v_exp_f32 v85, v85
    v_exp_f32 v86, v86
    v_exp_f32 v87, v87
    s_add_u32 m0, s8, 16384
    s_add_u32 s60, s67, 16384
    v_pk_add_f32 v[84:85], v[84:85], 1.0 op_sel_hi:[1,0]
    buffer_load_dwordx4 v1, s[40:43], s60 offen offset:0 sc1 lds
    v_pk_add_f32 v[86:87], v[86:87], 1.0 op_sel_hi:[1,0]
    v_rcp_f32 v84, v84
    v_rcp_f32 v85, v85
    v_rcp_f32 v86, v86
    v_rcp_f32 v87, v87
    v_pk_mul_f32 v[68:69], v[68:69], v[84:85]
    v_pk_mul_f32 v[70:71], v[70:71], v[86:87]
    buffer_load_dwordx4 v1, s[40:43], s60 offen offset:1024 sc1 lds
    v_cvt_pk_bf16_f32 v32, v64, v65
    v_cvt_pk_bf16_f32 v33, v66, v67
    v_cvt_pk_bf16_f32 v34, v68, v69
    v_cvt_pk_bf16_f32 v35, v70, v71
    v_pk_mul_f32 v[88:89], v[72:73], v[72:73]
    v_pk_fma_f32 v[88:89], v[88:89], s[76:77], v[124:125] op_sel_hi:[1,0,1]
    v_pk_mul_f32 v[88:89], v[88:89], v[72:73]
    v_pk_mul_f32 v[90:91], v[74:75], v[74:75]
    s_add_u32 s60, s3, 0
    v_pk_fma_f32 v[90:91], v[90:91], s[76:77], v[124:125] op_sel_hi:[1,0,1]
    s_add_u32 m0, s64, 0
    s_nop 0
    buffer_load_dwordx4 v57, s[40:43], s60 offen offset:0 sc1 lds
    v_pk_mul_f32 v[90:91], v[90:91], v[74:75]
    v_exp_f32 v88, v88
    v_exp_f32 v89, v89
    v_exp_f32 v90, v90
    v_exp_f32 v91, v91
    v_pk_add_f32 v[88:89], v[88:89], 1.0 op_sel_hi:[1,0]
    v_pk_add_f32 v[90:91], v[90:91], 1.0 op_sel_hi:[1,0]
    buffer_load_dwordx4 v57, s[40:43], s60 offen offset:1024 sc1 lds
    v_rcp_f32 v88, v88
    v_rcp_f32 v89, v89
    v_rcp_f32 v90, v90
    v_rcp_f32 v91, v91
    v_pk_mul_f32 v[72:73], v[72:73], v[88:89]
    v_pk_mul_f32 v[74:75], v[74:75], v[90:91]
    v_pk_mul_f32 v[92:93], v[76:77], v[76:77]
    buffer_load_dwordx4 v57, s[40:43], s60 offen offset:2048 sc1 lds
    v_pk_fma_f32 v[92:93], v[92:93], s[76:77], v[124:125] op_sel_hi:[1,0,1]
    v_pk_mul_f32 v[92:93], v[92:93], v[76:77]
    v_pk_mul_f32 v[94:95], v[78:79], v[78:79]
    v_pk_fma_f32 v[94:95], v[94:95], s[76:77], v[124:125] op_sel_hi:[1,0,1]
    v_pk_mul_f32 v[94:95], v[94:95], v[78:79]
    v_exp_f32 v92, v92
    v_exp_f32 v93, v93
    v_exp_f32 v94, v94
    buffer_load_dwordx4 v57, s[40:43], s60 offen offset:3072 sc1 lds
    v_exp_f32 v95, v95
    v_pk_add_f32 v[92:93], v[92:93], 1.0 op_sel_hi:[1,0]
    v_pk_add_f32 v[94:95], v[94:95], 1.0 op_sel_hi:[1,0]
    v_rcp_f32 v92, v92
    v_rcp_f32 v93, v93
    s_add_u32 s60, s3, 262144
    v_rcp_f32 v94, v94
    s_add_u32 m0, s64, 4096
    s_nop 0
    buffer_load_dwordx4 v57, s[40:43], s60 offen offset:0 sc1 lds
    v_rcp_f32 v95, v95
    v_pk_mul_f32 v[76:77], v[76:77], v[92:93]
    v_pk_mul_f32 v[78:79], v[78:79], v[94:95]
    v_cvt_pk_bf16_f32 v36, v72, v73
    v_cvt_pk_bf16_f32 v37, v74, v75
    v_cvt_pk_bf16_f32 v38, v76, v77
    v_cvt_pk_bf16_f32 v39, v78, v79
    buffer_store_dwordx4 v[32:35], v1, s[40:43], s36 offen offset:0 sc1
    buffer_store_dwordx4 v[36:39], v1, s[40:43], s36 offen offset:1024 sc1
    buffer_load_dwordx4 v57, s[40:43], s60 offen offset:1024 sc1 lds
    buffer_load_dwordx4 v57, s[40:43], s60 offen offset:2048 sc1 lds
    buffer_load_dwordx4 v57, s[40:43], s60 offen offset:3072 sc1 lds
L_join:
    s_waitcnt vmcnt(10)
    s_barrier
    ds_read_b128 v[16:19], v1 offset:0
    s_mov_b32 s60, 0
    s_add_u32 m0, s64, 8192
    ds_read_b128 v[20:23], v56 offset:0
    buffer_load_dwordx4 v2, s[24:27], s60 offen offset:0  lds
    ds_read_b128 v[24:27], v1 offset:1024
    ds_read_b128 v[28:31], v56 offset:768
    ds_read_b128 v[32:35], v1 offset:2048
    ds_read_b128 v[36:39], v56 offset:1536
    ds_read_b128 v[40:43], v12 offset:0
    ds_read_b64_tr_b16 v[44:45], v49 offset:0
    ds_read_b64_tr_b16 v[46:47], v49 offset:512
    s_waitcnt vmcnt(9)
    ds_read_b64_tr_b16 v[128:129], v58 offset:0
    ds_read_b64_tr_b16 v[130:131], v58 offset:1024
    ds_read_b64_tr_b16 v[132:133], v58 offset:512
    ds_read_b64_tr_b16 v[134:135], v58 offset:1536
    s_waitcnt lgkmcnt(0)
    buffer_load_dwordx4 v3, s[24:27], s60 offen offset:1024  lds
    v_mfma_f32_16x16x32_bf16 v[64:67], v[16:19], v[128:131], 0
    ds_read_b128 a[224:227], v1 offset:5376
    v_mfma_f32_16x16x32_bf16 v[88:91], v[16:19], v[132:135], 0
    ds_read_b64_tr_b16 a[252:253], v49 offset:1024
    ds_read_b64_tr_b16 a[254:255], v49 offset:1536
    v_mfma_f32_16x16x32_bf16 v[68:71], v[20:23], v[128:131], 0
    buffer_load_dwordx4 v4, s[24:27], s60 offen offset:2048  lds
    ds_read_b128 a[228:231], v56 offset:5376
    v_mfma_f32_16x16x32_bf16 v[92:95], v[20:23], v[132:135], 0
    v_mfma_f32_16x16x32_bf16 v[72:75], v[24:27], v[128:131], 0
    ds_read_b128 a[232:235], v1 offset:6400
    buffer_load_dwordx4 v5, s[24:27], s60 offen offset:3072  lds
    v_mfma_f32_16x16x32_bf16 v[96:99], v[24:27], v[132:135], 0
    s_add_u32 s60, s3, 524288
    s_add_u32 m0, s64, 0
    v_mfma_f32_16x16x32_bf16 v[76:79], v[28:31], v[128:131], 0
    s_waitcnt vmcnt(10)
    ds_read_b64_tr_b16 v[136:137], v58 offset:2048
    ds_read_b64_tr_b16 v[138:139], v58 offset:3072
    ds_read_b128 a[236:239], v56 offset:6144
    buffer_load_dwordx4 v57, s[40:43], s60 offen offset:0 sc1 lds
    v_mfma_f32_16x16x32_bf16 v[100:103], v[28:31], v[132:135], 0
    ds_read_b64_tr_b16 v[140:141], v58 offset:2560
    ds_read_b64_tr_b16 v[142:143], v58 offset:3584
    v_mfma_f32_16x16x32_bf16 v[80:83], v[128:131], v[32:35], 0
    ds_read_b128 a[240:243], v1 offset:7424
    buffer_load_dwordx4 v57, s[40:43], s60 offen offset:1024 sc1 lds
    v_mfma_f32_16x16x32_bf16 v[104:107], v[132:135], v[32:35], 0
    s_waitcnt vmcnt(8)
    ds_read_b64_tr_b16 v[144:145], v58 offset:4096
    v_mfma_f32_16x16x32_bf16 v[84:87], v[128:131], v[36:39], 0
    ds_read_b128 a[244:247], v56 offset:6912
    ds_read_b64_tr_b16 v[146:147], v58 offset:5120
    v_mfma_f32_16x16x32_bf16 v[108:111], v[132:135], v[36:39], 0
    s_waitcnt lgkmcnt(4)
    buffer_load_dwordx4 v57, s[40:43], s60 offen offset:2048 sc1 lds
    s_mov_b64 exec, 1
    buffer_store_dword v61, v15, s[40:43], s66 offen offset:0 sc1
    s_mov_b64 exec, -1
    v_mfma_f32_16x16x32_bf16 v[112:115], v[40:43], v[44:47], 0
    ds_read_b128 a[248:251], v12 offset:5376
    ds_read_b64_tr_b16 v[148:149], v58 offset:4608
    v_mfma_f32_16x16x32_bf16 v[116:119], v[44:47], v[40:43], 0
    ds_read_b64_tr_b16 v[150:151], v58 offset:5632
    buffer_load_dwordx4 v57, s[40:43], s60 offen offset:3072 sc1 lds
    v_mfma_f32_16x16x32_bf16 v[64:67], a[224:227], v[136:139], v[64:67]
    ds_read_b128 v[16:19], v1 offset:10752
    s_mov_b32 s60, 131072
    s_add_u32 m0, s64, 4096
    v_mfma_f32_16x16x32_bf16 v[88:91], a[224:227], v[140:143], v[88:91]
    s_waitcnt vmcnt(9)
    ds_read_b64_tr_b16 v[152:153], v58 offset:6144
    ds_read_b64_tr_b16 v[154:155], v58 offset:7168
    ds_read_b64_tr_b16 v[44:45], v49 offset:2048
    s_waitcnt lgkmcnt(4)
    buffer_load_dwordx4 v2, s[24:27], s60 offen offset:0  lds
    ds_read_b64_tr_b16 v[46:47], v49 offset:2560
    v_mfma_f32_16x16x32_bf16 v[68:71], a[228:231], v[136:139], v[68:71]
    ds_read_b128 v[20:23], v56 offset:10752
    ds_read_b64_tr_b16 v[156:157], v58 offset:6656
    v_mfma_f32_16x16x32_bf16 v[92:95], a[228:231], v[140:143], v[92:95]
    ds_read_b64_tr_b16 v[158:159], v58 offset:7680
    buffer_load_dwordx4 v3, s[24:27], s60 offen offset:1024  lds
    v_mfma_f32_16x16x32_bf16 v[72:75], a[232:235], v[136:139], v[72:75]
    ds_read_b128 v[24:27], v1 offset:11776
    s_waitcnt vmcnt(9)
    ds_read_b64_tr_b16 a[0:1], v6 offset:8192
    v_mfma_f32_16x16x32_bf16 v[96:99], a[232:235], v[140:143], v[96:99]
    ds_read_b64_tr_b16 a[4:5], v7 offset:8192
    s_waitcnt lgkmcnt(3)
    buffer_load_dwordx4 v4, s[24:27], s60 offen offset:2048  lds
    v_mfma_f32_16x16x32_bf16 v[76:79], a[236:239], v[136:139], v[76:79]
    ds_read_b128 v[28:31], v56 offset:11520
    ds_read_b64_tr_b16 a[8:9], v8 offset:8192
    v_mfma_f32_16x16x32_bf16 v[100:103], a[236:239], v[140:143], v[100:103]
    ds_read_b64_tr_b16 a[12:13], v9 offset:8192
    buffer_load_dwordx4 v5, s[24:27], s60 offen offset:3072  lds
    v_mfma_f32_16x16x32_bf16 v[80:83], v[136:139], a[240:243], v[80:83]
    ds_read_b128 v[32:35], v1 offset:12800
    s_mov_b32 s60, 262144
    s_add_u32 m0, s64, 8192
    v_mfma_f32_16x16x32_bf16 v[104:107], v[140:143], a[240:243], v[104:107]
    s_waitcnt vmcnt(9)
    ds_read_b64_tr_b16 a[2:3], v6 offset:10240
    ds_read_b64_tr_b16 a[6:7], v7 offset:10240
    v_mfma_f32_16x16x32_bf16 v[84:87], v[136:139], a[244:247], v[84:87]
    s_waitcnt lgkmcnt(3)
    buffer_load_dwordx4 v2, s[24:27], s60 offen offset:0  lds
    ds_read_b128 v[36:39], v56 offset:12288
    v_mfma_f32_16x16x32_bf16 v[108:111], v[140:143], a[244:247], v[108:111]
    ds_read_b64_tr_b16 a[10:11], v8 offset:10240
    ds_read_b64_tr_b16 a[14:15], v9 offset:10240
    v_mfma_f32_16x16x32_bf16 v[112:115], a[248:251], a[252:255], v[112:115]
    ds_read_b128 v[40:43], v12 offset:10752
    buffer_load_dwordx4 v3, s[24:27], s60 offen offset:1024  lds
    v_mfma_f32_16x16x32_bf16 v[116:119], a[252:255], a[248:251], v[116:119]
    s_waitcnt vmcnt(9)
    ds_read_b64_tr_b16 v[160:161], v58 offset:0
    v_mfma_f32_16x16x32_bf16 v[64:67], v[16:19], v[144:147], v[64:67]
    ds_read_b128 a[224:227], v1 offset:16128
    ds_read_b64_tr_b16 v[162:163], v58 offset:1024
    v_mfma_f32_16x16x32_bf16 v[88:91], v[16:19], v[148:151], v[88:91]
    s_waitcnt lgkmcnt(4)
    buffer_load_dwordx4 v4, s[24:27], s60 offen offset:2048  lds
    ds_read_b64_tr_b16 a[252:253], v49 offset:3072
    ds_read_b64_tr_b16 a[254:255], v49 offset:3584
    v_mfma_f32_16x16x32_bf16 v[68:71], v[20:23], v[144:147], v[68:71]
    ds_read_b128 a[228:231], v56 offset:16128
    ds_read_b64_tr_b16 v[164:165], v58 offset:512
    v_mfma_f32_16x16x32_bf16 v[92:95], v[20:23], v[148:151], v[92:95]
    ds_read_b64_tr_b16 v[166:167], v58 offset:1536
    buffer_load_dwordx4 v5, s[24:27], s60 offen offset:3072  lds
    v_mfma_f32_16x16x32_bf16 v[72:75], v[24:27], v[144:147], v[72:75]
    ds_read_b128 a[232:235], v1 offset:17152
    s_add_u32 s60, s3, 786432
    s_add_u32 m0, s64, 0
    v_mfma_f32_16x16x32_bf16 v[96:99], v[24:27], v[148:151], v[96:99]
    s_waitcnt vmcnt(8)
    ds_read_b64_tr_b16 v[168:169], v58 offset:2048
    ds_read_b64_tr_b16 v[170:171], v58 offset:3072
    v_mfma_f32_16x16x32_bf16 v[76:79], v[28:31], v[144:147], v[76:79]
    s_waitcnt lgkmcnt(3)
    buffer_load_dwordx4 v57, s[40:43], s60 offen offset:0 sc1 lds
    ds_read_b128 a[236:239], v56 offset:16896
    v_mfma_f32_16x16x32_bf16 v[100:103], v[28:31], v[148:151], v[100:103]
    ds_read_b64_tr_b16 v[172:173], v58 offset:2560
    ds_read_b64_tr_b16 v[174:175], v58 offset:3584
    v_mfma_f32_16x16x32_bf16 v[80:83], v[144:147], v[32:35], v[80:83]
    ds_read_b128 a[240:243], v1 offset:18176
    buffer_load_dwordx4 v57, s[40:43], s60 offen offset:1024 sc1 lds
    v_mfma_f32_16x16x32_bf16 v[104:107], v[148:151], v[32:35], v[104:107]
    s_waitcnt vmcnt(8)
    ds_read_b64_tr_b16 a[16:17], v6 offset:4096
    v_mfma_f32_16x16x32_bf16 v[84:87], v[144:147], v[36:39], v[84:87]
    ds_read_b128 a[244:247], v56 offset:17664
    ds_read_b64_tr_b16 a[20:21], v7 offset:4096
    v_mfma_f32_16x16x32_bf16 v[108:111], v[148:151], v[36:39], v[108:111]
    s_waitcnt lgkmcnt(4)
    buffer_load_dwordx4 v57, s[40:43], s60 offen offset:2048 sc1 lds
    v_mfma_f32_16x16x32_bf16 v[112:115], v[40:43], v[44:47], v[112:115]
    ds_read_b128 a[248:251], v12 offset:16128
    ds_read_b64_tr_b16 a[24:25], v8 offset:4096
    v_mfma_f32_16x16x32_bf16 v[116:119], v[44:47], v[40:43], v[116:119]
    ds_read_b64_tr_b16 a[28:29], v9 offset:4096
    buffer_load_dwordx4 v57, s[40:43], s60 offen offset:3072 sc1 lds
    v_mfma_f32_16x16x32_bf16 v[64:67], a[224:227], v[152:155], v[64:67]
    ds_read_b128 v[16:19], v1 offset:21504
    s_mov_b32 s60, 393216
    s_add_u32 m0, s64, 4096
    v_mfma_f32_16x16x32_bf16 v[88:91], a[224:227], v[156:159], v[88:91]
    s_waitcnt vmcnt(8)
    ds_read_b64_tr_b16 a[18:19], v6 offset:6144
    ds_read_b64_tr_b16 a[22:23], v7 offset:6144
    ds_read_b64_tr_b16 v[44:45], v49 offset:4096
    s_waitcnt lgkmcnt(4)
    buffer_load_dwordx4 v2, s[24:27], s60 offen offset:0  lds
    ds_read_b64_tr_b16 v[46:47], v49 offset:4608
    v_mfma_f32_16x16x32_bf16 v[68:71], a[228:231], v[152:155], v[68:71]
    ds_read_b128 v[20:23], v56 offset:21504
    ds_read_b64_tr_b16 a[26:27], v8 offset:6144
    v_mfma_f32_16x16x32_bf16 v[92:95], a[228:231], v[156:159], v[92:95]
    ds_read_b64_tr_b16 a[30:31], v9 offset:6144
    buffer_load_dwordx4 v3, s[24:27], s60 offen offset:1024  lds
    v_mfma_f32_16x16x32_bf16 v[72:75], a[232:235], v[152:155], v[72:75]
    ds_read_b128 v[24:27], v1 offset:22528
    s_waitcnt vmcnt(8)
    ds_read_b64_tr_b16 a[32:33], v6 offset:8192
    v_mfma_f32_16x16x32_bf16 v[96:99], a[232:235], v[156:159], v[96:99]
    ds_read_b64_tr_b16 a[36:37], v7 offset:8192
    s_waitcnt lgkmcnt(3)
    buffer_load_dwordx4 v4, s[24:27], s60 offen offset:2048  lds
    v_mfma_f32_16x16x32_bf16 v[76:79], a[236:239], v[152:155], v[76:79]
    ds_read_b128 v[28:31], v56 offset:22272
    ds_read_b64_tr_b16 a[40:41], v8 offset:8192
    v_mfma_f32_16x16x32_bf16 v[100:103], a[236:239], v[156:159], v[100:103]
    ds_read_b64_tr_b16 a[44:45], v9 offset:8192
    buffer_load_dwordx4 v5, s[24:27], s60 offen offset:3072  lds
    v_mfma_f32_16x16x32_bf16 v[80:83], v[152:155], a[240:243], v[80:83]
    ds_read_b128 v[32:35], v1 offset:23552
    s_mov_b32 s60, 524288
    s_add_u32 m0, s64, 8192
    v_mfma_f32_16x16x32_bf16 v[104:107], v[156:159], a[240:243], v[104:107]
    s_waitcnt vmcnt(8)
    ds_read_b64_tr_b16 a[34:35], v6 offset:10240
    ds_read_b64_tr_b16 a[38:39], v7 offset:10240
    v_mfma_f32_16x16x32_bf16 v[84:87], v[152:155], a[244:247], v[84:87]
    s_waitcnt lgkmcnt(3)
    buffer_load_dwordx4 v2, s[24:27], s60 offen offset:0  lds
    ds_read_b128 v[36:39], v56 offset:23040
    v_mfma_f32_16x16x32_bf16 v[108:111], v[156:159], a[244:247], v[108:111]
    ds_read_b64_tr_b16 a[42:43], v8 offset:10240
    ds_read_b64_tr_b16 a[46:47], v9 offset:10240
    v_mfma_f32_16x16x32_bf16 v[112:115], a[248:251], a[252:255], v[112:115]
    ds_read_b128 v[40:43], v12 offset:21504
    buffer_load_dwordx4 v3, s[24:27], s60 offen offset:1024  lds
    v_mfma_f32_16x16x32_bf16 v[116:119], a[252:255], a[248:251], v[116:119]
    s_waitcnt vmcnt(8)
    ds_read_b64_tr_b16 v[176:177], v58 offset:0
    v_mfma_f32_16x16x32_bf16 v[64:67], v[16:19], v[160:163], v[64:67]
    ds_read_b128 a[224:227], v1 offset:26880
    ds_read_b64_tr_b16 v[178:179], v58 offset:1024
    v_mfma_f32_16x16x32_bf16 v[88:91], v[16:19], v[164:167], v[88:91]
    s_waitcnt lgkmcnt(4)
    buffer_load_dwordx4 v4, s[24:27], s60 offen offset:2048  lds
    ds_read_b64_tr_b16 a[252:253], v49 offset:5120
    ds_read_b64_tr_b16 a[254:255], v49 offset:5632
    v_mfma_f32_16x16x32_bf16 v[68:71], v[20:23], v[160:163], v[68:71]
    ds_read_b128 a[228:231], v56 offset:26880
    ds_read_b64_tr_b16 v[180:181], v58 offset:512
    v_mfma_f32_16x16x32_bf16 v[92:95], v[20:23], v[164:167], v[92:95]
    ds_read_b64_tr_b16 v[182:183], v58 offset:1536
    buffer_load_dwordx4 v5, s[24:27], s60 offen offset:3072  lds
    v_mfma_f32_16x16x32_bf16 v[72:75], v[24:27], v[160:163], v[72:75]
    ds_read_b128 a[232:235], v1 offset:27904
    s_add_u32 s60, s3, 1048576
    s_add_u32 m0, s64, 0
    v_mfma_f32_16x16x32_bf16 v[96:99], v[24:27], v[164:167], v[96:99]
    s_waitcnt vmcnt(8)
    ds_read_b64_tr_b16 v[184:185], v58 offset:2048
    ds_read_b64_tr_b16 v[186:187], v58 offset:3072
    v_mfma_f32_16x16x32_bf16 v[76:79], v[28:31], v[160:163], v[76:79]
    s_waitcnt lgkmcnt(3)
    buffer_load_dwordx4 v57, s[40:43], s60 offen offset:0 sc1 lds
    ds_read_b128 a[236:239], v56 offset:27648
    v_mfma_f32_16x16x32_bf16 v[100:103], v[28:31], v[164:167], v[100:103]
    ds_read_b64_tr_b16 v[188:189], v58 offset:2560
    ds_read_b64_tr_b16 v[190:191], v58 offset:3584
    v_mfma_f32_16x16x32_bf16 v[80:83], v[160:163], v[32:35], v[80:83]
    ds_read_b128 a[240:243], v1 offset:28928
    buffer_load_dwordx4 v57, s[40:43], s60 offen offset:1024 sc1 lds
    v_mfma_f32_16x16x32_bf16 v[104:107], v[164:167], v[32:35], v[104:107]
    s_waitcnt vmcnt(8)
    ds_read_b64_tr_b16 a[48:49], v6 offset:4096
    v_mfma_f32_16x16x32_bf16 v[84:87], v[160:163], v[36:39], v[84:87]
    ds_read_b128 a[244:247], v56 offset:28416
    ds_read_b64_tr_b16 a[52:53], v7 offset:4096
    v_mfma_f32_16x16x32_bf16 v[108:111], v[164:167], v[36:39], v[108:111]
    s_waitcnt lgkmcnt(4)
    buffer_load_dwordx4 v57, s[40:43], s60 offen offset:2048 sc1 lds
    v_mfma_f32_16x16x32_bf16 v[112:115], v[40:43], v[44:47], v[112:115]
    ds_read_b128 a[248:251], v12 offset:26880
    ds_read_b64_tr_b16 a[56:57], v8 offset:4096
    v_mfma_f32_16x16x32_bf16 v[116:119], v[44:47], v[40:43], v[116:119]
    ds_read_b64_tr_b16 a[60:61], v9 offset:4096
    buffer_load_dwordx4 v57, s[40:43], s60 offen offset:3072 sc1 lds
    v_mfma_f32_16x16x32_bf16 v[64:67], a[224:227], v[168:171], v[64:67]
    ds_read_b128 v[16:19], v1 offset:32256
    s_mov_b32 s60, 655360
    s_add_u32 m0, s64, 4096
    v_mfma_f32_16x16x32_bf16 v[88:91], a[224:227], v[172:175], v[88:91]
    s_waitcnt vmcnt(8)
    ds_read_b64_tr_b16 a[50:51], v6 offset:6144
    ds_read_b64_tr_b16 a[54:55], v7 offset:6144
    ds_read_b64_tr_b16 v[44:45], v49 offset:6144
    s_waitcnt lgkmcnt(4)
    buffer_load_dwordx4 v2, s[24:27], s60 offen offset:0  lds
    ds_read_b64_tr_b16 v[46:47], v49 offset:6656
    v_mfma_f32_16x16x32_bf16 v[68:71], a[228:231], v[168:171], v[68:71]
    ds_read_b128 v[20:23], v56 offset:32256
    ds_read_b64_tr_b16 a[58:59], v8 offset:6144
    v_mfma_f32_16x16x32_bf16 v[92:95], a[228:231], v[172:175], v[92:95]
    ds_read_b64_tr_b16 a[62:63], v9 offset:6144
    buffer_load_dwordx4 v3, s[24:27], s60 offen offset:1024  lds
    v_mfma_f32_16x16x32_bf16 v[72:75], a[232:235], v[168:171], v[72:75]
    ds_read_b128 v[24:27], v1 offset:33280
    s_waitcnt vmcnt(8)
    ds_read_b64_tr_b16 a[64:65], v6 offset:8192
    v_mfma_f32_16x16x32_bf16 v[96:99], a[232:235], v[172:175], v[96:99]
    ds_read_b64_tr_b16 a[68:69], v7 offset:8192
    s_waitcnt lgkmcnt(3)
    buffer_load_dwordx4 v4, s[24:27], s60 offen offset:2048  lds
    v_mfma_f32_16x16x32_bf16 v[76:79], a[236:239], v[168:171], v[76:79]
    ds_read_b128 v[28:31], v56 offset:33024
    ds_read_b64_tr_b16 a[72:73], v8 offset:8192
    v_mfma_f32_16x16x32_bf16 v[100:103], a[236:239], v[172:175], v[100:103]
    ds_read_b64_tr_b16 a[76:77], v9 offset:8192
    buffer_load_dwordx4 v5, s[24:27], s60 offen offset:3072  lds
    v_mfma_f32_16x16x32_bf16 v[80:83], v[168:171], a[240:243], v[80:83]
    ds_read_b128 v[32:35], v1 offset:34304
    s_mov_b32 s60, 786432
    s_add_u32 m0, s64, 8192
    v_mfma_f32_16x16x32_bf16 v[104:107], v[172:175], a[240:243], v[104:107]
    s_waitcnt vmcnt(8)
    ds_read_b64_tr_b16 a[66:67], v6 offset:10240
    ds_read_b64_tr_b16 a[70:71], v7 offset:10240
    v_mfma_f32_16x16x32_bf16 v[84:87], v[168:171], a[244:247], v[84:87]
    s_waitcnt lgkmcnt(3)
    buffer_load_dwordx4 v2, s[24:27], s60 offen offset:0  lds
    ds_read_b128 v[36:39], v56 offset:33792
    v_mfma_f32_16x16x32_bf16 v[108:111], v[172:175], a[244:247], v[108:111]
    ds_read_b64_tr_b16 a[74:75], v8 offset:10240
    ds_read_b64_tr_b16 a[78:79], v9 offset:10240
    v_mfma_f32_16x16x32_bf16 v[112:115], a[248:251], a[252:255], v[112:115]
    ds_read_b128 v[40:43], v12 offset:32256
    buffer_load_dwordx4 v3, s[24:27], s60 offen offset:1024  lds
    v_mfma_f32_16x16x32_bf16 v[116:119], a[252:255], a[248:251], v[116:119]
    s_waitcnt vmcnt(8)
    ds_read_b64_tr_b16 v[192:193], v58 offset:0
    v_mfma_f32_16x16x32_bf16 v[64:67], v[16:19], v[176:179], v[64:67]
    ds_read_b128 a[224:227], v1 offset:37632
    ds_read_b64_tr_b16 v[194:195], v58 offset:1024
    v_mfma_f32_16x16x32_bf16 v[88:91], v[16:19], v[180:183], v[88:91]
    s_waitcnt lgkmcnt(4)
    buffer_load_dwordx4 v4, s[24:27], s60 offen offset:2048  lds
    ds_read_b64_tr_b16 a[252:253], v49 offset:7168
    ds_read_b64_tr_b16 a[254:255], v49 offset:7680
    v_mfma_f32_16x16x32_bf16 v[68:71], v[20:23], v[176:179], v[68:71]
    ds_read_b128 a[228:231], v56 offset:37632
    ds_read_b64_tr_b16 v[196:197], v58 offset:512
    v_mfma_f32_16x16x32_bf16 v[92:95], v[20:23], v[180:183], v[92:95]
    ds_read_b64_tr_b16 v[198:199], v58 offset:1536
    buffer_load_dwordx4 v5, s[24:27], s60 offen offset:3072  lds
    v_mfma_f32_16x16x32_bf16 v[72:75], v[24:27], v[176:179], v[72:75]
    ds_read_b128 a[232:235], v1 offset:38656
    s_add_u32 s60, s3, 1310720
    s_add_u32 m0, s64, 0
    v_mfma_f32_16x16x32_bf16 v[96:99], v[24:27], v[180:183], v[96:99]
    s_waitcnt vmcnt(8)
    ds_read_b64_tr_b16 v[200:201], v58 offset:2048
    ds_read_b64_tr_b16 v[202:203], v58 offset:3072
    v_mfma_f32_16x16x32_bf16 v[76:79], v[28:31], v[176:179], v[76:79]
    s_waitcnt lgkmcnt(3)
    buffer_load_dwordx4 v57, s[40:43], s60 offen offset:0 sc1 lds
    ds_read_b128 a[236:239], v56 offset:38400
    v_mfma_f32_16x16x32_bf16 v[100:103], v[28:31], v[180:183], v[100:103]
    ds_read_b64_tr_b16 v[204:205], v58 offset:2560
    ds_read_b64_tr_b16 v[206:207], v58 offset:3584
    v_mfma_f32_16x16x32_bf16 v[80:83], v[176:179], v[32:35], v[80:83]
    ds_read_b128 a[240:243], v1 offset:39680
    buffer_load_dwordx4 v57, s[40:43], s60 offen offset:1024 sc1 lds
    v_mfma_f32_16x16x32_bf16 v[104:107], v[180:183], v[32:35], v[104:107]
    s_waitcnt vmcnt(8)
    ds_read_b64_tr_b16 a[80:81], v6 offset:4096
    v_mfma_f32_16x16x32_bf16 v[84:87], v[176:179], v[36:39], v[84:87]
    ds_read_b128 a[244:247], v56 offset:39168
    ds_read_b64_tr_b16 a[84:85], v7 offset:4096
    v_mfma_f32_16x16x32_bf16 v[108:111], v[180:183], v[36:39], v[108:111]
    s_waitcnt lgkmcnt(4)
    buffer_load_dwordx4 v57, s[40:43], s60 offen offset:2048 sc1 lds
    v_mfma_f32_16x16x32_bf16 v[112:115], v[40:43], v[44:47], v[112:115]
    ds_read_b128 a[248:251], v12 offset:37632
    ds_read_b64_tr_b16 a[88:89], v8 offset:4096
    v_mfma_f32_16x16x32_bf16 v[116:119], v[44:47], v[40:43], v[116:119]
    ds_read_b64_tr_b16 a[92:93], v9 offset:4096
    buffer_load_dwordx4 v57, s[40:43], s60 offen offset:3072 sc1 lds
    v_mfma_f32_16x16x32_bf16 v[64:67], a[224:227], v[184:187], v[64:67]
    ds_read_b128 v[16:19], v1 offset:43008
    s_mov_b32 s60, 917504
    s_add_u32 m0, s64, 4096
    v_mfma_f32_16x16x32_bf16 v[88:91], a[224:227], v[188:191], v[88:91]
    s_waitcnt vmcnt(8)
    ds_read_b64_tr_b16 a[82:83], v6 offset:6144
    ds_read_b64_tr_b16 a[86:87], v7 offset:6144
    ds_read_b64_tr_b16 v[44:45], v49 offset:8192
    s_waitcnt lgkmcnt(4)
    buffer_load_dwordx4 v2, s[24:27], s60 offen offset:0  lds
    ds_read_b64_tr_b16 v[46:47], v49 offset:8704
    v_mfma_f32_16x16x32_bf16 v[68:71], a[228:231], v[184:187], v[68:71]
    ds_read_b128 v[20:23], v56 offset:43008
    ds_read_b64_tr_b16 a[90:91], v8 offset:6144
    v_mfma_f32_16x16x32_bf16 v[92:95], a[228:231], v[188:191], v[92:95]
    ds_read_b64_tr_b16 a[94:95], v9 offset:6144
    buffer_load_dwordx4 v3, s[24:27], s60 offen offset:1024  lds
    v_mfma_f32_16x16x32_bf16 v[72:75], a[232:235], v[184:187], v[72:75]
    ds_read_b128 v[24:27], v1 offset:44032
    s_waitcnt vmcnt(8)
    ds_read_b64_tr_b16 a[96:97], v6 offset:8192
    v_mfma_f32_16x16x32_bf16 v[96:99], a[232:235], v[188:191], v[96:99]
    ds_read_b64_tr_b16 a[100:101], v7 offset:8192
    s_waitcnt lgkmcnt(3)
    buffer_load_dwordx4 v4, s[24:27], s60 offen offset:2048  lds
    v_mfma_f32_16x16x32_bf16 v[76:79], a[236:239], v[184:187], v[76:79]
    ds_read_b128 v[28:31], v56 offset:43776
    ds_read_b64_tr_b16 a[104:105], v8 offset:8192
    v_mfma_f32_16x16x32_bf16 v[100:103], a[236:239], v[188:191], v[100:103]
    ds_read_b64_tr_b16 a[108:109], v9 offset:8192
    buffer_load_dwordx4 v5, s[24:27], s60 offen offset:3072  lds
    v_mfma_f32_16x16x32_bf16 v[80:83], v[184:187], a[240:243], v[80:83]
    ds_read_b128 v[32:35], v1 offset:45056
    s_mov_b32 s60, 1048576
    s_add_u32 m0, s64, 8192
    v_mfma_f32_16x16x32_bf16 v[104:107], v[188:191], a[240:243], v[104:107]
    s_waitcnt vmcnt(8)
    ds_read_b64_tr_b16 a[98:99], v6 offset:10240
    ds_read_b64_tr_b16 a[102:103], v7 offset:10240
    v_mfma_f32_16x16x32_bf16 v[84:87], v[184:187], a[244:247], v[84:87]
    s_waitcnt lgkmcnt(3)
    buffer_load_dwordx4 v2, s[24:27], s60 offen offset:0  lds
    ds_read_b128 v[36:39], v56 offset:44544
    v_mfma_f32_16x16x32_bf16 v[108:111], v[188:191], a[244:247], v[108:111]
    ds_read_b64_tr_b16 a[106:107], v8 offset:10240
    ds_read_b64_tr_b16 a[110:111], v9 offset:10240
    v_mfma_f32_16x16x32_bf16 v[112:115], a[248:251], a[252:255], v[112:115]
    ds_read_b128 v[40:43], v12 offset:43008
    buffer_load_dwordx4 v3, s[24:27], s60 offen offset:1024  lds
    v_mfma_f32_16x16x32_bf16 v[116:119], a[252:255], a[248:251], v[116:119]
    s_waitcnt vmcnt(8)
    ds_read_b64_tr_b16 v[208:209], v58 offset:0
    v_mfma_f32_16x16x32_bf16 v[64:67], v[16:19], v[192:195], v[64:67]
    ds_read_b128 a[224:227], v11 offset:0
    ds_read_b64_tr_b16 v[210:211], v58 offset:1024
    v_mfma_f32_16x16x32_bf16 v[88:91], v[16:19], v[196:199], v[88:91]
    s_waitcnt lgkmcnt(4)
    buffer_load_dwordx4 v4, s[24:27], s60 offen offset:2048  lds
    ds_read_b64_tr_b16 a[252:253], v49 offset:9216
    ds_read_b64_tr_b16 a[254:255], v49 offset:9728
    v_mfma_f32_16x16x32_bf16 v[68:71], v[20:23], v[192:195], v[68:71]
    ds_read_b128 a[228:231], v60 offset:0
    ds_read_b64_tr_b16 v[212:213], v58 offset:512
    v_mfma_f32_16x16x32_bf16 v[92:95], v[20:23], v[196:199], v[92:95]
    ds_read_b64_tr_b16 v[214:215], v58 offset:1536
    buffer_load_dwordx4 v5, s[24:27], s60 offen offset:3072  lds
    v_mfma_f32_16x16x32_bf16 v[72:75], v[24:27], v[192:195], v[72:75]
    ds_read_b128 a[232:235], v11 offset:1024
    s_add_u32 s60, s3, 1572864
    s_add_u32 m0, s64, 0
    v_mfma_f32_16x16x32_bf16 v[96:99], v[24:27], v[196:199], v[96:99]
    s_waitcnt vmcnt(8)
    ds_read_b64_tr_b16 v[216:217], v58 offset:2048
    ds_read_b64_tr_b16 v[218:219], v58 offset:3072
    v_mfma_f32_16x16x32_bf16 v[76:79], v[28:31], v[192:195], v[76:79]
    s_waitcnt lgkmcnt(3)
    buffer_load_dwordx4 v57, s[40:43], s60 offen offset:0 sc1 lds
    ds_read_b128 a[236:239], v60 offset:768
    v_mfma_f32_16x16x32_bf16 v[100:103], v[28:31], v[196:199], v[100:103]
    ds_read_b64_tr_b16 v[220:221], v58 offset:2560
    ds_read_b64_tr_b16 v[222:223], v58 offset:3584
    v_mfma_f32_16x16x32_bf16 v[80:83], v[192:195], v[32:35], v[80:83]
    ds_read_b128 a[240:243], v11 offset:2048
    buffer_load_dwordx4 v57, s[40:43], s60 offen offset:1024 sc1 lds
    v_mfma_f32_16x16x32_bf16 v[104:107], v[196:199], v[32:35], v[104:107]
    s_waitcnt vmcnt(8)
    ds_read_b64_tr_b16 a[112:113], v6 offset:4096
    v_mfma_f32_16x16x32_bf16 v[84:87], v[192:195], v[36:39], v[84:87]
    ds_read_b128 a[244:247], v60 offset:1536
    ds_read_b64_tr_b16 a[116:117], v7 offset:4096
    v_mfma_f32_16x16x32_bf16 v[108:111], v[196:199], v[36:39], v[108:111]
    s_waitcnt lgkmcnt(4)
    buffer_load_dwordx4 v57, s[40:43], s60 offen offset:2048 sc1 lds
    v_mfma_f32_16x16x32_bf16 v[112:115], v[40:43], v[44:47], v[112:115]
    ds_read_b128 a[248:251], v13 offset:0
    ds_read_b64_tr_b16 a[120:121], v8 offset:4096
    v_mfma_f32_16x16x32_bf16 v[116:119], v[44:47], v[40:43], v[116:119]
    ds_read_b64_tr_b16 a[124:125], v9 offset:4096
    buffer_load_dwordx4 v57, s[40:43], s60 offen offset:3072 sc1 lds
    v_mfma_f32_16x16x32_bf16 v[64:67], a[224:227], v[200:203], v[64:67]
    ds_read_b128 v[16:19], v11 offset:5376
    s_mov_b32 s60, 1179648
    s_add_u32 m0, s64, 4096
    v_mfma_f32_16x16x32_bf16 v[88:91], a[224:227], v[204:207], v[88:91]
    s_waitcnt vmcnt(8)
    ds_read_b64_tr_b16 a[114:115], v6 offset:6144
    ds_read_b64_tr_b16 a[118:119], v7 offset:6144
    ds_read_b64_tr_b16 v[44:45], v49 offset:10240
    s_waitcnt lgkmcnt(4)
    buffer_load_dwordx4 v2, s[24:27], s60 offen offset:0  lds
    ds_read_b64_tr_b16 v[46:47], v49 offset:10752
    v_mfma_f32_16x16x32_bf16 v[68:71], a[228:231], v[200:203], v[68:71]
    ds_read_b128 v[20:23], v60 offset:5376
    ds_read_b64_tr_b16 a[122:123], v8 offset:6144
    v_mfma_f32_16x16x32_bf16 v[92:95], a[228:231], v[204:207], v[92:95]
    ds_read_b64_tr_b16 a[126:127], v9 offset:6144
    buffer_load_dwordx4 v3, s[24:27], s60 offen offset:1024  lds
    v_mfma_f32_16x16x32_bf16 v[72:75], a[232:235], v[200:203], v[72:75]
    ds_read_b128 v[24:27], v11 offset:6400
    s_waitcnt vmcnt(8)
    ds_read_b64_tr_b16 a[128:129], v6 offset:8192
    v_mfma_f32_16x16x32_bf16 v[96:99], a[232:235], v[204:207], v[96:99]
    ds_read_b64_tr_b16 a[132:133], v7 offset:8192
    s_waitcnt lgkmcnt(3)
    buffer_load_dwordx4 v4, s[24:27], s60 offen offset:2048  lds
    v_mfma_f32_16x16x32_bf16 v[76:79], a[236:239], v[200:203], v[76:79]
    ds_read_b128 v[28:31], v60 offset:6144
    ds_read_b64_tr_b16 a[136:137], v8 offset:8192
    v_mfma_f32_16x16x32_bf16 v[100:103], a[236:239], v[204:207], v[100:103]
    ds_read_b64_tr_b16 a[140:141], v9 offset:8192
    buffer_load_dwordx4 v5, s[24:27], s60 offen offset:3072  lds
    v_mfma_f32_16x16x32_bf16 v[80:83], v[200:203], a[240:243], v[80:83]
    ds_read_b128 v[32:35], v11 offset:7424
    s_mov_b32 s60, 1310720
    s_add_u32 m0, s64, 8192
    v_mfma_f32_16x16x32_bf16 v[104:107], v[204:207], a[240:243], v[104:107]
    s_waitcnt vmcnt(8)
    ds_read_b64_tr_b16 a[130:131], v6 offset:10240
    ds_read_b64_tr_b16 a[134:135], v7 offset:10240
    v_mfma_f32_16x16x32_bf16 v[84:87], v[200:203], a[244:247], v[84:87]
    s_waitcnt lgkmcnt(3)
    buffer_load_dwordx4 v2, s[24:27], s60 offen offset:0  lds
    ds_read_b128 v[36:39], v60 offset:6912
    v_mfma_f32_16x16x32_bf16 v[108:111], v[204:207], a[244:247], v[108:111]
    ds_read_b64_tr_b16 a[138:139], v8 offset:10240
    ds_read_b64_tr_b16 a[142:143], v9 offset:10240
    v_mfma_f32_16x16x32_bf16 v[112:115], a[248:251], a[252:255], v[112:115]
    ds_read_b128 v[40:43], v13 offset:5376
    buffer_load_dwordx4 v3, s[24:27], s60 offen offset:1024  lds
    v_mfma_f32_16x16x32_bf16 v[116:119], a[252:255], a[248:251], v[116:119]
    s_waitcnt vmcnt(8)
    ds_read_b64_tr_b16 v[224:225], v58 offset:0
    v_mfma_f32_16x16x32_bf16 v[64:67], v[16:19], v[208:211], v[64:67]
    ds_read_b128 a[224:227], v11 offset:10752
    ds_read_b64_tr_b16 v[226:227], v58 offset:1024
    v_mfma_f32_16x16x32_bf16 v[88:91], v[16:19], v[212:215], v[88:91]
    s_waitcnt lgkmcnt(4)
    buffer_load_dwordx4 v4, s[24:27], s60 offen offset:2048  lds
    ds_read_b64_tr_b16 a[252:253], v49 offset:11264
    ds_read_b64_tr_b16 a[254:255], v49 offset:11776
    v_mfma_f32_16x16x32_bf16 v[68:71], v[20:23], v[208:211], v[68:71]
    ds_read_b128 a[228:231], v60 offset:10752
    ds_read_b64_tr_b16 v[228:229], v58 offset:512
    v_mfma_f32_16x16x32_bf16 v[92:95], v[20:23], v[212:215], v[92:95]
    ds_read_b64_tr_b16 v[230:231], v58 offset:1536
    buffer_load_dwordx4 v5, s[24:27], s60 offen offset:3072  lds
    v_mfma_f32_16x16x32_bf16 v[72:75], v[24:27], v[208:211], v[72:75]
    ds_read_b128 a[232:235], v11 offset:11776
    s_mov_b32 s60, 1441792
    s_add_u32 m0, s64, 0
    v_mfma_f32_16x16x32_bf16 v[96:99], v[24:27], v[212:215], v[96:99]
    s_waitcnt vmcnt(8)
    ds_read_b64_tr_b16 v[232:233], v58 offset:2048
    ds_read_b64_tr_b16 v[234:235], v58 offset:3072
    v_mfma_f32_16x16x32_bf16 v[76:79], v[28:31], v[208:211], v[76:79]
    s_waitcnt lgkmcnt(3)
    buffer_load_dwordx4 v2, s[24:27], s60 offen offset:0  lds
    ds_read_b128 a[236:239], v60 offset:11520
    v_mfma_f32_16x16x32_bf16 v[100:103], v[28:31], v[212:215], v[100:103]
    ds_read_b64_tr_b16 v[236:237], v58 offset:2560
    ds_read_b64_tr_b16 v[238:239], v58 offset:3584
    v_mfma_f32_16x16x32_bf16 v[80:83], v[208:211], v[32:35], v[80:83]
    ds_read_b128 a[240:243], v11 offset:12800
    buffer_load_dwordx4 v3, s[24:27], s60 offen offset:1024  lds
    v_mfma_f32_16x16x32_bf16 v[104:107], v[212:215], v[32:35], v[104:107]
    s_waitcnt vmcnt(8)
    ds_read_b64_tr_b16 a[144:145], v6 offset:4096
    v_mfma_f32_16x16x32_bf16 v[84:87], v[208:211], v[36:39], v[84:87]
    ds_read_b128 a[244:247], v60 offset:12288
    ds_read_b64_tr_b16 a[148:149], v7 offset:4096
    v_mfma_f32_16x16x32_bf16 v[108:111], v[212:215], v[36:39], v[108:111]
    s_waitcnt lgkmcnt(4)
    buffer_load_dwordx4 v4, s[24:27], s60 offen offset:2048  lds
    v_mfma_f32_16x16x32_bf16 v[112:115], v[40:43], v[44:47], v[112:115]
    ds_read_b128 a[248:251], v13 offset:10752
    ds_read_b64_tr_b16 a[152:153], v8 offset:4096
    v_mfma_f32_16x16x32_bf16 v[116:119], v[44:47], v[40:43], v[116:119]
    ds_read_b64_tr_b16 a[156:157], v9 offset:4096
    buffer_load_dwordx4 v5, s[24:27], s60 offen offset:3072  lds
    v_mfma_f32_16x16x32_bf16 v[64:67], a[224:227], v[216:219], v[64:67]
    ds_read_b128 v[16:19], v11 offset:16128
    v_mfma_f32_16x16x32_bf16 v[88:91], a[224:227], v[220:223], v[88:91]
    ds_read_b64_tr_b16 v[44:45], v49 offset:12288
    ds_read_b64_tr_b16 v[46:47], v49 offset:12800
    v_mfma_f32_16x16x32_bf16 v[68:71], a[228:231], v[216:219], v[68:71]
    buffer_load_dwordx2 v[124:125], v62, s[40:43], 0 offen sc1
    ds_read_b128 v[20:23], v60 offset:16128
    v_mfma_f32_16x16x32_bf16 v[92:95], a[228:231], v[220:223], v[92:95]
    s_mov_b32 s60, 1572864
    s_add_u32 m0, s64, 4096
    v_mfma_f32_16x16x32_bf16 v[72:75], a[232:235], v[216:219], v[72:75]
    s_waitcnt vmcnt(9)
    ds_read_b64_tr_b16 a[146:147], v6 offset:6144
    ds_read_b64_tr_b16 a[150:151], v7 offset:6144
    ds_read_b128 v[24:27], v11 offset:17152
    s_waitcnt lgkmcnt(7)
    buffer_load_dwordx4 v2, s[24:27], s60 offen offset:0  lds
    v_mfma_f32_16x16x32_bf16 v[96:99], a[232:235], v[220:223], v[96:99]
    ds_read_b64_tr_b16 a[154:155], v8 offset:6144
    ds_read_b64_tr_b16 a[158:159], v9 offset:6144
    v_mfma_f32_16x16x32_bf16 v[76:79], a[236:239], v[216:219], v[76:79]
    ds_read_b128 v[28:31], v60 offset:16896
    buffer_load_dwordx4 v3, s[24:27], s60 offen offset:1024  lds
    v_mfma_f32_16x16x32_bf16 v[100:103], a[236:239], v[220:223], v[100:103]
    s_waitcnt vmcnt(9)
    ds_read_b64_tr_b16 a[160:161], v6 offset:8192
    v_mfma_f32_16x16x32_bf16 v[80:83], v[216:219], a[240:243], v[80:83]
    ds_read_b128 v[32:35], v11 offset:18176
    ds_read_b64_tr_b16 a[164:165], v7 offset:8192
    v_mfma_f32_16x16x32_bf16 v[104:107], v[220:223], a[240:243], v[104:107]
    s_waitcnt lgkmcnt(4)
    buffer_load_dwordx4 v4, s[24:27], s60 offen offset:2048  lds
    v_mfma_f32_16x16x32_bf16 v[84:87], v[216:219], a[244:247], v[84:87]
    ds_read_b128 v[36:39], v60 offset:17664
    ds_read_b64_tr_b16 a[168:169], v8 offset:8192
    v_mfma_f32_16x16x32_bf16 v[108:111], v[220:223], a[244:247], v[108:111]
    ds_read_b64_tr_b16 a[172:173], v9 offset:8192
    buffer_load_dwordx4 v5, s[24:27], s60 offen offset:3072  lds
    v_mfma_f32_16x16x32_bf16 v[112:115], a[248:251], a[252:255], v[112:115]
    ds_read_b128 v[40:43], v13 offset:16128
    s_mov_b32 s60, 1703936
    s_add_u32 m0, s64, 8192
    v_mfma_f32_16x16x32_bf16 v[116:119], a[252:255], a[248:251], v[116:119]
    s_waitcnt vmcnt(9)
    ds_read_b64_tr_b16 a[162:163], v6 offset:10240
    ds_read_b64_tr_b16 a[166:167], v7 offset:10240
    v_mfma_f32_16x16x32_bf16 v[64:67], v[16:19], v[224:227], v[64:67]
    s_waitcnt lgkmcnt(3)
    buffer_load_dwordx4 v2, s[24:27], s60 offen offset:0  lds
    ds_read_b128 a[224:227], v11 offset:21504
    v_mfma_f32_16x16x32_bf16 v[88:91], v[16:19], v[228:231], v[88:91]
    ds_read_b64_tr_b16 a[252:253], v49 offset:13312
    ds_read_b64_tr_b16 a[254:255], v49 offset:13824
    v_mfma_f32_16x16x32_bf16 v[68:71], v[20:23], v[224:227], v[68:71]
    ds_read_b64_tr_b16 a[170:171], v8 offset:10240
    ds_read_b64_tr_b16 a[174:175], v9 offset:10240
    ds_read_b128 a[228:231], v60 offset:21504
    buffer_load_dwordx4 v3, s[24:27], s60 offen offset:1024  lds
    v_mfma_f32_16x16x32_bf16 v[92:95], v[20:23], v[228:231], v[92:95]
    s_waitcnt vmcnt(9)
    ds_read_b64_tr_b16 a[176:177], v6 offset:0
    v_mfma_f32_16x16x32_bf16 v[72:75], v[24:27], v[224:227], v[72:75]
    ds_read_b128 a[232:235], v11 offset:22528
    ds_read_b64_tr_b16 a[180:181], v7 offset:0
    v_mfma_f32_16x16x32_bf16 v[96:99], v[24:27], v[228:231], v[96:99]
    s_waitcnt lgkmcnt(4)
    buffer_load_dwordx4 v4, s[24:27], s60 offen offset:2048  lds
    v_mfma_f32_16x16x32_bf16 v[76:79], v[28:31], v[224:227], v[76:79]
    ds_read_b128 a[236:239], v60 offset:22272
    ds_read_b64_tr_b16 a[184:185], v8 offset:0
    v_mfma_f32_16x16x32_bf16 v[100:103], v[28:31], v[228:231], v[100:103]
    ds_read_b64_tr_b16 a[188:189], v9 offset:0
    buffer_load_dwordx4 v5, s[24:27], s60 offen offset:3072  lds
    v_mfma_f32_16x16x32_bf16 v[80:83], v[224:227], v[32:35], v[80:83]
    s_waitcnt vmcnt(8)
    v_min_u32 v124, v124, v125
    v_cmp_eq_u32 vcc, 0, v124
    s_nop 4
    s_cbranch_vccnz L_spin_21
L_go_22:
    ds_read_b128 a[240:243], v11 offset:23552
    s_add_u32 s62, s68, 0
    v_mfma_f32_16x16x32_bf16 v[104:107], v[228:231], v[32:35], v[104:107]
    buffer_load_dwordx4 v[128:131], v1, s[40:43], s62 offen offset:0 sc1
    ds_read_b64_tr_b16 a[178:179], v6 offset:2048
    v_mfma_f32_16x16x32_bf16 v[84:87], v[224:227], v[36:39], v[84:87]
    ds_read_b128 a[244:247], v60 offset:23040
    ds_read_b64_tr_b16 a[182:183], v7 offset:2048
    v_mfma_f32_16x16x32_bf16 v[108:111], v[228:231], v[36:39], v[108:111]
    buffer_load_dwordx4 v[132:135], v1, s[40:43], s62 offen offset:1024 sc1
    ds_read_b64_tr_b16 a[186:187], v8 offset:2048
    v_mfma_f32_16x16x32_bf16 v[112:115], v[40:43], v[44:47], v[112:115]
    ds_read_b128 a[248:251], v13 offset:21504
    ds_read_b64_tr_b16 a[190:191], v9 offset:2048
    v_mfma_f32_16x16x32_bf16 v[116:119], v[44:47], v[40:43], v[116:119]
    s_waitcnt lgkmcnt(13)
    buffer_load_dwordx4 v[136:139], v1, s[40:43], s62 offen offset:2048 sc1
    v_mfma_f32_16x16x32_bf16 v[64:67], a[224:227], v[232:235], v[64:67]
    s_waitcnt vmcnt(9)
    ds_read_b64_tr_b16 a[192:193], v6 offset:4096
    v_mfma_f32_16x16x32_bf16 v[88:91], a[224:227], v[236:239], v[88:91]
    ds_read_b64_tr_b16 a[196:197], v7 offset:4096
    buffer_load_dwordx4 v[140:143], v1, s[40:43], s62 offen offset:3072 sc1
    v_mfma_f32_16x16x32_bf16 v[68:71], a[228:231], v[232:235], v[68:71]
    ds_read_b64_tr_b16 a[200:201], v8 offset:4096
    ds_read_b64_tr_b16 a[204:205], v9 offset:4096
    v_mfma_f32_16x16x32_bf16 v[92:95], a[228:231], v[236:239], v[92:95]
    s_waitcnt lgkmcnt(13)
    s_add_u32 s62, s68, 4096
    v_mfma_f32_16x16x32_bf16 v[72:75], a[232:235], v[232:235], v[72:75]
    buffer_load_dwordx4 v[144:147], v1, s[40:43], s62 offen offset:0 sc1
    s_waitcnt vmcnt(9)
    ds_read_b64_tr_b16 a[194:195], v6 offset:6144
    v_mfma_f32_16x16x32_bf16 v[96:99], a[232:235], v[236:239], v[96:99]
    ds_read_b64_tr_b16 a[198:199], v7 offset:6144
    v_mfma_f32_16x16x32_bf16 v[76:79], a[236:239], v[232:235], v[76:79]
    buffer_load_dwordx4 v[148:151], v1, s[40:43], s62 offen offset:1024 sc1
    ds_read_b64_tr_b16 a[202:203], v8 offset:6144
    v_mfma_f32_16x16x32_bf16 v[100:103], a[236:239], v[236:239], v[100:103]
    s_waitcnt lgkmcnt(11)
    ds_read_b64_tr_b16 a[206:207], v9 offset:6144
    v_mfma_f32_16x16x32_bf16 v[80:83], v[232:235], a[240:243], v[80:83]
    buffer_load_dwordx4 v[152:155], v1, s[40:43], s62 offen offset:2048 sc1
    s_waitcnt vmcnt(9)
    ds_read_b64_tr_b16 a[208:209], v6 offset:8192
    v_mfma_f32_16x16x32_bf16 v[104:107], v[236:239], a[240:243], v[104:107]
    ds_read_b64_tr_b16 a[212:213], v7 offset:8192
    v_mfma_f32_16x16x32_bf16 v[84:87], v[232:235], a[244:247], v[84:87]
    buffer_load_dwordx4 v[156:159], v1, s[40:43], s62 offen offset:3072 sc1
    ds_read_b64_tr_b16 a[216:217], v8 offset:8192
    v_mfma_f32_16x16x32_bf16 v[108:111], v[236:239], a[244:247], v[108:111]
    s_waitcnt lgkmcnt(12)
    ds_read_b64_tr_b16 a[220:221], v9 offset:8192
    v_mfma_f32_16x16x32_bf16 v[112:115], a[248:251], a[252:255], v[112:115]
    s_add_u32 s62, s68, 8192
    buffer_load_dwordx4 v[160:163], v1, s[40:43], s62 offen offset:0 sc1
    v_mfma_f32_16x16x32_bf16 v[116:119], a[252:255], a[248:251], v[116:119]
    v_cvt_pk_bf16_f32 v32, v96, v97
    v_cvt_pk_bf16_f32 v33, v98, v99
    v_cvt_pk_bf16_f32 v34, v100, v101
    v_cvt_pk_bf16_f32 v35, v102, v103
    s_waitcnt vmcnt(9)
    ds_read_b64_tr_b16 a[210:211], v6 offset:10240
    ds_read_b64_tr_b16 a[214:215], v7 offset:10240
    ds_write_b128 v50, v[32:35] offset:2048
    buffer_load_dwordx4 v[164:167], v1, s[40:43], s62 offen offset:1024 sc1
    v_cvt_pk_bf16_f32 v40, v104, v105
    v_cvt_pk_bf16_f32 v46, v108, v109
    v_cvt_pk_bf16_f32 v41, v106, v107
    v_cvt_pk_bf16_f32 v47, v110, v111
    ds_write_b64 v50, v[40:41] offset:3072
    ds_write_b64 v50, v[46:47] offset:3080
    ds_read_b64_tr_b16 a[218:219], v8 offset:10240
    v_cvt_pk_bf16_f32 v96, v112, v113
    ds_read_b64_tr_b16 a[222:223], v9 offset:10240
    buffer_load_dwordx4 v[168:171], v1, s[40:43], s62 offen offset:2048 sc1
    v_cvt_pk_bf16_f32 v97, v114, v115
    v_cvt_pk_bf16_f32 v98, v116, v117
    v_cvt_pk_bf16_f32 v99, v118, v119
    v_cndmask_b32 v96, v98, v96, s[78:79]
    v_cndmask_b32 v97, v99, v97, s[78:79]
    ds_write_b64 v51, v[96:97]
    v_cvt_pk_bf16_f32 v28, v72, v73
    v_cvt_pk_bf16_f32 v29, v74, v75
    v_cvt_pk_bf16_f32 v30, v76, v77
    buffer_load_dwordx4 v[172:175], v1, s[40:43], s62 offen offset:3072 sc1
    v_cvt_pk_bf16_f32 v31, v78, v79
    v_cvt_pk_bf16_f32 v16, v64, v65
    v_cvt_pk_bf16_f32 v17, v66, v67
    v_cvt_pk_bf16_f32 v18, v68, v69
    v_cvt_pk_bf16_f32 v19, v70, v71
    v_and_b32 v18, v54, v18
    v_and_b32 v19, v54, v19
    v_cvt_pk_bf16_f32 v20, v88, v89
    s_add_u32 s62, s68, 12288
    buffer_load_dwordx4 v[176:179], v1, s[40:43], s62 offen offset:0 sc1
    v_cvt_pk_bf16_f32 v21, v90, v91
    v_cvt_pk_bf16_f32 v22, v92, v93
    v_cvt_pk_bf16_f32 v23, v94, v95
    v_and_b32 v22, v54, v22
    v_and_b32 v23, v54, v23
    s_waitcnt lgkmcnt(0)
    s_barrier
    buffer_load_dwordx4 v[180:183], v1, s[40:43], s62 offen offset:1024 sc1
    ds_read_b128 v[24:27], v50
    ds_read_b64 v[36:37], v50 offset:1024
    ds_read_b64 v[42:43], v50 offset:1032
    v_mfma_f32_16x16x32_bf16 v[72:75], v[28:31], v[20:23], 0
    s_add_u32 s62, s68, 57344
    v_mfma_f32_16x16x32_bf16 v[76:79], v[32:35], v[20:23], 0
    buffer_load_dwordx4 v[184:187], v1, s[40:43], s62 offen offset:0 sc1
    v_mfma_f32_16x16x32_bf16 v[68:71], v[28:31], v[16:19], 0
    v_cvt_pk_bf16_f32 v38, v80, v81
    v_cvt_pk_bf16_f32 v44, v84, v85
    v_cvt_pk_bf16_f32 v39, v82, v83
    v_cvt_pk_bf16_f32 v45, v86, v87
    s_waitcnt lgkmcnt(2)
    v_mfma_f32_16x16x32_bf16 v[64:67], v[24:27], v[16:19], v[244:247]
    buffer_load_dwordx4 v[188:191], v1, s[40:43], s62 offen offset:1024 sc1
    v_cndmask_b32 v76, v76, v77, s[70:71]
    v_cndmask_b32 v78, v78, v79, s[70:71]
    v_cndmask_b32 v72, v72, v73, s[70:71]
    v_cndmask_b32 v74, v74, v75, s[70:71]
    v_cndmask_b32 v90, v72, v76, s[72:73]
    v_cndmask_b32 v91, v74, v78, s[74:75]
    v_pk_mul_f32 v[90:91], v[90:91], v[250:251]
    v_max_f32 v93, v90, v91
    v_cndmask_b32 v68, v68, v69, s[70:71]
    buffer_load_dwordx4 v[192:195], v1, s[40:43], s62 offen offset:2048 sc1
    v_cndmask_b32 v70, v70, v71, s[70:71]
    v_cndmask_b32 v64, v64, v65, s[70:71]
    v_cndmask_b32 v66, v66, v67, s[70:71]
    v_cndmask_b32 v88, v64, v68, s[72:73]
    v_cndmask_b32 v89, v66, v70, s[74:75]
    v_pk_mul_f32 v[88:89], v[88:89], v[248:249]
    v_max_f32 v92, v88, v89
    s_nop 1
    v_permlane32_swap_b32 v92, v93
    v_max_f32 v92, v92, v93
    buffer_load_dwordx4 v[196:199], v1, s[40:43], s62 offen offset:3072 sc1
    v_mov_b32 v93, v92
    s_nop 1
    v_permlane16_swap_b32 v92, v93
    v_max_f32 v92, v92, v93
    v_mov_b32 v93, v92
    s_nop 1
    v_permlane32_swap_b32 v92, v93
    v_sub_f32 v88, v88, v92
    v_sub_f32 v89, v89, v92
    v_sub_f32 v90, v90, v93
    s_add_u32 s62, s68, 61440
    buffer_load_dwordx4 v[200:203], v1, s[40:43], s62 offen offset:0 sc1
    v_sub_f32 v91, v91, v93
    v_exp_f32 v88, v88
    v_exp_f32 v89, v89
    v_exp_f32 v90, v90
    v_exp_f32 v91, v91
    buffer_load_dwordx4 v[204:207], v1, s[40:43], s62 offen offset:1024 sc1
    v_add_f32 v92, v88, v89
    v_add_f32 v93, v90, v91
    v_pk_mul_f32 v[88:89], v[88:89], v[252:253]
    v_pk_mul_f32 v[90:91], v[90:91], v[254:255]
    v_permlane32_swap_b32 v92, v93
    v_add_f32 v92, v92, v93
    v_mov_b32 v93, v92
    s_nop 1
    v_permlane16_swap_b32 v92, v93
    v_add_f32 v92, v92, v93
    buffer_load_dwordx4 v[208:211], v1, s[40:43], s62 offen offset:2048 sc1
    v_rcp_f32 v92, v92
    s_nop 0
    v_mov_b32 v93, v92
    s_nop 1
    v_permlane32_swap_b32 v92, v93
    v_mul_f32 v88, v88, v92
    v_mul_f32 v89, v89, v92
    v_mul_f32 v90, v90, v93
    v_mul_f32 v91, v91, v93
    v_cvt_pk_bf16_f32 v88, v88, v88
    buffer_load_dwordx4 v[212:215], v1, s[40:43], s62 offen offset:3072 sc1
    v_cvt_pk_bf16_f32 v89, v89, v89
    v_cvt_pk_bf16_f32 v90, v90, v90
    v_cvt_pk_bf16_f32 v91, v91, v91
    v_and_b32 v96, v88, v240
    v_and_b32 v97, v89, v241
    v_and_b32 v98, v88, v242
    v_and_b32 v99, v89, v243
    v_and_b32 v100, v90, v240
    s_add_u32 s62, s68, 65536
    buffer_load_dwordx4 v[216:219], v1, s[40:43], s62 offen offset:0 sc1
    v_and_b32 v101, v91, v241
    v_and_b32 v102, v90, v242
    v_and_b32 v103, v91, v243
    s_waitcnt lgkmcnt(0)
    v_mfma_f32_16x16x32_bf16 v[104:107], v[36:39], v[96:99], 0
    v_mfma_f32_16x16x32_bf16 v[108:111], v[42:45], v[96:99], 0
    buffer_load_dwordx4 v[220:223], v1, s[40:43], s62 offen offset:1024 sc1
    s_add_u32 m0, s21, 0
    v_mfma_f32_16x16x32_bf16 v[112:115], v[38:41], v[100:103], 0
    s_add_u32 s61, s22, 0
    v_mfma_f32_16x16x32_bf16 v[116:119], v[44:47], v[100:103], 0
    buffer_load_dwordx4 v52, s[12:15], s61 offen lds
    s_nop 0
    v_cvt_pk_bf16_f32 v16, v104, v105
    v_cvt_pk_bf16_f32 v17, v106, v107
    v_cvt_pk_bf16_f32 v18, v108, v109
    v_cvt_pk_bf16_f32 v19, v110, v111
    v_cvt_pk_bf16_f32 v20, v112, v113
    v_cvt_pk_bf16_f32 v21, v114, v115
    s_add_u32 m0, s21, 1024
    v_cvt_pk_bf16_f32 v22, v116, v117
    s_add_u32 s61, s22, 7168
    buffer_load_dwordx4 v52, s[12:15], s61 offen lds
    v_cvt_pk_bf16_f32 v23, v118, v119
    v_and_b32 v18, v54, v18
    v_and_b32 v19, v54, v19
    v_and_b32 v22, v54, v22
    v_and_b32 v23, v54, v23
    buffer_store_dwordx4 v[16:19], v1, s[40:43], s23 offen sc1
    buffer_store_dwordx4 v[20:23], v1, s[40:43], s63 offen sc1
L_g2:
    v_lshlrev_b32 v24, 16, v126
    v_lshlrev_b32 v25, 16, v126
    v_lshlrev_b32 v26, 16, v126
    v_lshlrev_b32 v27, 16, v126
    s_mov_b32 s76, 0xbfb8aa3b
    s_waitcnt vmcnt(27)
    v_mfma_f32_16x16x32_bf16 v[64:67], v[128:131], a[0:3], v[24:27]
    s_add_u32 m0, s21, 2048
    s_add_u32 s61, s22, 14336
    v_mfma_f32_16x16x32_bf16 v[80:83], v[128:131], a[4:7], 0
    v_mfma_f32_16x16x32_bf16 v[84:87], v[128:131], a[8:11], 0
    v_mfma_f32_16x16x32_bf16 v[88:91], v[128:131], a[12:15], 0
    s_waitcnt vmcnt(26)
    v_mfma_f32_16x16x32_bf16 v[64:67], v[132:135], a[16:19], v[64:67]
    v_mfma_f32_16x16x32_bf16 v[80:83], v[132:135], a[20:23], v[80:83]
    v_mfma_f32_16x16x32_bf16 v[84:87], v[132:135], a[24:27], v[84:87]
    v_mfma_f32_16x16x32_bf16 v[88:91], v[132:135], a[28:31], v[88:91]
    s_waitcnt vmcnt(25)
    v_lshrrev_b32 v16, 2, v14
    v_mfma_f32_16x16x32_bf16 v[64:67], v[136:139], a[32:35], v[64:67]
    v_bfe_u32 v17, v14, 3, 2
    v_lshlrev_b32 v16, 7, v16
    v_mfma_f32_16x16x32_bf16 v[80:83], v[136:139], a[36:39], v[80:83]
    v_and_b32 v19, 3, v14
    v_lshl_add_u32 v16, v19, 3, v16
    v_mfma_f32_16x16x32_bf16 v[84:87], v[136:139], a[40:43], v[84:87]
    v_xor_b32 v19, 0, v17
    v_lshl_add_u32 v56, v19, 5, v16
    v_mfma_f32_16x16x32_bf16 v[88:91], v[136:139], a[44:47], v[88:91]
    s_waitcnt vmcnt(24)
    v_xor_b32 v19, 1, v17
    v_mfma_f32_16x16x32_bf16 v[64:67], v[140:143], a[48:51], v[64:67]
    v_lshl_add_u32 v57, v19, 5, v16
    v_xor_b32 v19, 2, v17
    v_mfma_f32_16x16x32_bf16 v[80:83], v[140:143], a[52:55], v[80:83]
    v_lshl_add_u32 v58, v19, 5, v16
    v_xor_b32 v19, 3, v17
    v_mfma_f32_16x16x32_bf16 v[84:87], v[140:143], a[56:59], v[84:87]
    v_lshl_add_u32 v59, v19, 5, v16
    s_mul_i32 s57, s44, 2304
    v_mfma_f32_16x16x32_bf16 v[88:91], v[140:143], a[60:63], v[88:91]
    s_waitcnt vmcnt(23)
    s_add_u32 s57, s57, 151552
    v_mfma_f32_16x16x32_bf16 v[64:67], v[144:147], a[64:67], v[64:67]
    v_lshrrev_b32 v16, 3, v14
    v_lshlrev_b32 v16, 4, v16
    v_mfma_f32_16x16x32_bf16 v[80:83], v[144:147], a[68:71], v[80:83]
    v_add3_u32 v10, v16, v1, s57
    v_and_b32 v16, 15, v14
    v_mfma_f32_16x16x32_bf16 v[84:87], v[144:147], a[72:75], v[84:87]
    v_mul_u32_u24 v16, 144, v16
    v_lshrrev_b32 v17, 4, v14
    v_mfma_f32_16x16x32_bf16 v[88:91], v[144:147], a[76:79], v[88:91]
    s_waitcnt vmcnt(22)
    buffer_load_dwordx4 v52, s[12:15], s61 offen lds
    v_mfma_f32_16x16x32_bf16 v[64:67], v[148:151], a[80:83], v[64:67]
    s_add_u32 m0, s21, 3072
    s_add_u32 s61, s22, 21504
    v_mfma_f32_16x16x32_bf16 v[80:83], v[148:151], a[84:87], v[80:83]
    v_lshlrev_b32 v17, 3, v17
    v_add3_u32 v11, v16, v17, s57
    v_mfma_f32_16x16x32_bf16 v[84:87], v[148:151], a[88:91], v[84:87]
    v_mfma_f32_16x16x32_bf16 v[88:91], v[148:151], a[92:95], v[88:91]
    s_waitcnt vmcnt(22)
    buffer_load_dwordx4 v52, s[12:15], s61 offen lds
    v_mfma_f32_16x16x32_bf16 v[64:67], v[152:155], a[96:99], v[64:67]
    s_add_u32 m0, s21, 4096
    s_add_u32 s61, s22, 28672
    v_mfma_f32_16x16x32_bf16 v[80:83], v[152:155], a[100:103], v[80:83]
    v_mfma_f32_16x16x32_bf16 v[84:87], v[152:155], a[104:107], v[84:87]
    v_mfma_f32_16x16x32_bf16 v[88:91], v[152:155], a[108:111], v[88:91]
    s_waitcnt vmcnt(22)
    buffer_load_dwordx4 v52, s[12:15], s61 offen lds
    v_mfma_f32_16x16x32_bf16 v[64:67], v[156:159], a[112:115], v[64:67]
    s_add_u32 m0, s21, 5120
    s_add_u32 s61, s22, 35840
    v_mfma_f32_16x16x32_bf16 v[80:83], v[156:159], a[116:119], v[80:83]
    v_mfma_f32_16x16x32_bf16 v[84:87], v[156:159], a[120:123], v[84:87]
    v_mfma_f32_16x16x32_bf16 v[88:91], v[156:159], a[124:127], v[88:91]
    s_waitcnt vmcnt(22)
    buffer_load_dwordx4 v52, s[12:15], s61 offen lds
    v_mfma_f32_16x16x32_bf16 v[64:67], v[160:163], a[128:131], v[64:67]
    s_add_u32 m0, s21, 6144
    s_add_u32 s61, s22, 43008
    v_mfma_f32_16x16x32_bf16 v[80:83], v[160:163], a[132:135], v[80:83]
    v_mfma_f32_16x16x32_bf16 v[84:87], v[160:163], a[136:139], v[84:87]
    v_mfma_f32_16x16x32_bf16 v[88:91], v[160:163], a[140:143], v[88:91]
    s_waitcnt vmcnt(22)
    buffer_load_dwordx4 v52, s[12:15], s61 offen lds
    v_mfma_f32_16x16x32_bf16 v[64:67], v[164:167], a[144:147], v[64:67]
    s_add_u32 m0, s21, 7168
    s_add_u32 s61, s22, 50176
    v_mfma_f32_16x16x32_bf16 v[80:83], v[164:167], a[148:151], v[80:83]
    v_mfma_f32_16x16x32_bf16 v[84:87], v[164:167], a[152:155], v[84:87]
    v_mfma_f32_16x16x32_bf16 v[88:91], v[164:167], a[156:159], v[88:91]
    s_waitcnt vmcnt(22)
    buffer_load_dwordx4 v52, s[12:15], s61 offen lds
    v_mfma_f32_16x16x32_bf16 v[64:67], v[168:171], a[160:163], v[64:67]
    s_add_u32 m0, s21, 8192
    s_add_u32 s61, s22, 57344
    v_mfma_f32_16x16x32_bf16 v[80:83], v[168:171], a[164:167], v[80:83]
    v_mfma_f32_16x16x32_bf16 v[84:87], v[168:171], a[168:171], v[84:87]
    v_mfma_f32_16x16x32_bf16 v[88:91], v[168:171], a[172:175], v[88:91]
    s_waitcnt vmcnt(22)
    buffer_load_dwordx4 v52, s[12:15], s61 offen lds
    v_mfma_f32_16x16x32_bf16 v[64:67], v[172:175], a[176:179], v[64:67]
    s_add_u32 m0, s21, 9216
    s_add_u32 s61, s22, 64512
    v_mfma_f32_16x16x32_bf16 v[80:83], v[172:175], a[180:183], v[80:83]
    v_mfma_f32_16x16x32_bf16 v[84:87], v[172:175], a[184:187], v[84:87]
    v_mfma_f32_16x16x32_bf16 v[88:91], v[172:175], a[188:191], v[88:91]
    s_waitcnt vmcnt(22)
    s_waitcnt vmcnt(7)
    buffer_load_dwordx4 v52, s[12:15], s61 offen lds
    s_mov_b64 exec, 1
    buffer_store_dword v61, v15, s[40:43], s66 offen offset:128 sc1
    s_mov_b64 exec, -1
    v_mfma_f32_16x16x32_bf16 v[64:67], v[176:179], a[192:195], v[64:67]
    s_add_u32 m0, s21, 10240
    s_add_u32 s61, s22, 71680
    v_mfma_f32_16x16x32_bf16 v[80:83], v[176:179], a[196:199], v[80:83]
    v_mfma_f32_16x16x32_bf16 v[84:87], v[176:179], a[200:203], v[84:87]
    v_mfma_f32_16x16x32_bf16 v[88:91], v[176:179], a[204:207], v[88:91]
    buffer_load_dwordx4 v52, s[12:15], s61 offen lds
    s_add_u32 m0, s21, 11264
    v_mfma_f32_16x16x32_bf16 v[64:67], v[180:183], a[208:211], v[64:67]
    s_add_u32 s61, s22, 78848
    v_mfma_f32_16x16x32_bf16 v[80:83], v[180:183], a[212:215], v[80:83]
    v_mfma_f32_16x16x32_bf16 v[84:87], v[180:183], a[216:219], v[84:87]
    v_mfma_f32_16x16x32_bf16 v[88:91], v[180:183], a[220:223], v[88:91]
    buffer_load_dwordx4 v52, s[12:15], s61 offen lds
    s_add_u32 m0, s21, 12288
    v_mfma_f32_16x16x32_bf16 v[68:71], v[184:187], a[0:3], v[24:27]
    s_add_u32 s61, s22, 86016
    v_mfma_f32_16x16x32_bf16 v[92:95], v[184:187], a[4:7], 0
    v_mfma_f32_16x16x32_bf16 v[96:99], v[184:187], a[8:11], 0
    v_mfma_f32_16x16x32_bf16 v[100:103], v[184:187], a[12:15], 0
    buffer_load_dwordx4 v52, s[12:15], s61 offen lds
    s_add_u32 m0, s21, 13312
    v_mfma_f32_16x16x32_bf16 v[68:71], v[188:191], a[16:19], v[68:71]
    s_add_u32 s61, s22, 93184
    v_mfma_f32_16x16x32_bf16 v[92:95], v[188:191], a[20:23], v[92:95]
    v_mfma_f32_16x16x32_bf16 v[96:99], v[188:191], a[24:27], v[96:99]
    v_mfma_f32_16x16x32_bf16 v[100:103], v[188:191], a[28:31], v[100:103]
    buffer_load_dwordx4 v52, s[12:15], s61 offen lds
    v_mfma_f32_16x16x32_bf16 v[68:71], v[192:195], a[32:35], v[68:71]
    v_mfma_f32_16x16x32_bf16 v[92:95], v[192:195], a[36:39], v[92:95]
    v_mfma_f32_16x16x32_bf16 v[96:99], v[192:195], a[40:43], v[96:99]
    v_mfma_f32_16x16x32_bf16 v[100:103], v[192:195], a[44:47], v[100:103]
    buffer_load_dwordx4 v[224:227], v1, s[40:43], s62 offen offset:2048 sc1
    v_mfma_f32_16x16x32_bf16 v[68:71], v[196:199], a[48:51], v[68:71]
    v_mfma_f32_16x16x32_bf16 v[92:95], v[196:199], a[52:55], v[92:95]
    v_mfma_f32_16x16x32_bf16 v[96:99], v[196:199], a[56:59], v[96:99]
    v_mfma_f32_16x16x32_bf16 v[100:103], v[196:199], a[60:63], v[100:103]
    buffer_load_dwordx4 v[228:231], v1, s[40:43], s62 offen offset:3072 sc1
    s_add_u32 s62, s68, 69632
    v_mfma_f32_16x16x32_bf16 v[68:71], v[200:203], a[64:67], v[68:71]
    v_mfma_f32_16x16x32_bf16 v[92:95], v[200:203], a[68:71], v[92:95]
    v_mfma_f32_16x16x32_bf16 v[96:99], v[200:203], a[72:75], v[96:99]
    v_mfma_f32_16x16x32_bf16 v[100:103], v[200:203], a[76:79], v[100:103]
    buffer_load_dwordx4 v[232:235], v1, s[40:43], s62 offen offset:0 sc1
    v_mfma_f32_16x16x32_bf16 v[68:71], v[204:207], a[80:83], v[68:71]
    v_mfma_f32_16x16x32_bf16 v[92:95], v[204:207], a[84:87], v[92:95]
    v_mfma_f32_16x16x32_bf16 v[96:99], v[204:207], a[88:91], v[96:99]
    v_mfma_f32_16x16x32_bf16 v[100:103], v[204:207], a[92:95], v[100:103]
    buffer_load_dwordx4 v[236:239], v1, s[40:43], s62 offen offset:1024 sc1
    s_add_u32 s62, s68, 114688
    v_mfma_f32_16x16x32_bf16 v[68:71], v[208:211], a[96:99], v[68:71]
    v_mfma_f32_16x16x32_bf16 v[92:95], v[208:211], a[100:103], v[92:95]
    v_mfma_f32_16x16x32_bf16 v[96:99], v[208:211], a[104:107], v[96:99]
    v_mfma_f32_16x16x32_bf16 v[100:103], v[208:211], a[108:111], v[100:103]
    buffer_load_dwordx4 v[128:131], v1, s[40:43], s62 offen offset:0 sc1
    v_mfma_f32_16x16x32_bf16 v[68:71], v[212:215], a[112:115], v[68:71]
    ds_write_b128 v120, v[80:83] offset:4096
    v_mfma_f32_16x16x32_bf16 v[92:95], v[212:215], a[116:119], v[92:95]
    buffer_load_dwordx4 v[132:135], v1, s[40:43], s62 offen offset:1024 sc1
    v_mfma_f32_16x16x32_bf16 v[96:99], v[212:215], a[120:123], v[96:99]
    v_mfma_f32_16x16x32_bf16 v[100:103], v[212:215], a[124:127], v[100:103]
    v_mfma_f32_16x16x32_bf16 v[68:71], v[216:219], a[128:131], v[68:71]
    ds_write_b128 v120, v[84:87] offset:8192
    buffer_load_dwordx4 v[136:139], v1, s[40:43], s62 offen offset:2048 sc1
    v_mfma_f32_16x16x32_bf16 v[92:95], v[216:219], a[132:135], v[92:95]
    v_mfma_f32_16x16x32_bf16 v[96:99], v[216:219], a[136:139], v[96:99]
    v_mfma_f32_16x16x32_bf16 v[100:103], v[216:219], a[140:143], v[100:103]
    v_mfma_f32_16x16x32_bf16 v[68:71], v[220:223], a[144:147], v[68:71]
    ds_write_b128 v120, v[88:91] offset:12288
    buffer_load_dwordx4 v[140:143], v1, s[40:43], s62 offen offset:3072 sc1
    v_mfma_f32_16x16x32_bf16 v[92:95], v[220:223], a[148:151], v[92:95]
    s_add_u32 s62, s68, 118784
    v_mfma_f32_16x16x32_bf16 v[96:99], v[220:223], a[152:155], v[96:99]
    v_mfma_f32_16x16x32_bf16 v[100:103], v[220:223], a[156:159], v[100:103]
    buffer_load_dwordx4 v[144:147], v1, s[40:43], s62 offen offset:0 sc1
    s_waitcnt vmcnt(8)
    v_mfma_f32_16x16x32_bf16 v[68:71], v[224:227], a[160:163], v[68:71]
    v_mfma_f32_16x16x32_bf16 v[92:95], v[224:227], a[164:167], v[92:95]
    v_mfma_f32_16x16x32_bf16 v[96:99], v[224:227], a[168:171], v[96:99]
    v_mfma_f32_16x16x32_bf16 v[100:103], v[224:227], a[172:175], v[100:103]
    s_waitcnt lgkmcnt(0)
    buffer_load_dwordx4 v[148:151], v1, s[40:43], s62 offen offset:1024 sc1
    s_barrier
    s_waitcnt vmcnt(8)
    v_mfma_f32_16x16x32_bf16 v[68:71], v[228:231], a[176:179], v[68:71]
    ds_read_b128 v[104:107], v121 offset:4096
    v_mfma_f32_16x16x32_bf16 v[92:95], v[228:231], a[180:183], v[92:95]
    ds_read_b128 v[108:111], v122 offset:8192
    buffer_load_dwordx4 v[152:155], v1, s[40:43], s62 offen offset:2048 sc1
    v_mfma_f32_16x16x32_bf16 v[96:99], v[228:231], a[184:187], v[96:99]
    ds_read_b128 v[112:115], v123 offset:12288
    v_mfma_f32_16x16x32_bf16 v[100:103], v[228:231], a[188:191], v[100:103]
    s_waitcnt vmcnt(8)
    v_mfma_f32_16x16x32_bf16 v[68:71], v[232:235], a[192:195], v[68:71]
    ds_read_b64_tr_b16 v[32:33], v56 offset:0
    v_mfma_f32_16x16x32_bf16 v[92:95], v[232:235], a[196:199], v[92:95]
    ds_read_b64_tr_b16 v[34:35], v56 offset:2048
    buffer_load_dwordx4 v[156:159], v1, s[40:43], s62 offen offset:3072 sc1
    v_mfma_f32_16x16x32_bf16 v[96:99], v[232:235], a[200:203], v[96:99]
    ds_read_b64_tr_b16 v[36:37], v57 offset:0
    s_add_u32 s62, s68, 122880
    v_mfma_f32_16x16x32_bf16 v[100:103], v[232:235], a[204:207], v[100:103]
    ds_read_b64_tr_b16 v[38:39], v57 offset:2048
    s_waitcnt vmcnt(8)
    v_mfma_f32_16x16x32_bf16 v[68:71], v[236:239], a[208:211], v[68:71]
    ds_read_b64_tr_b16 v[40:41], v58 offset:0
    s_waitcnt lgkmcnt(5)
    v_mfma_f32_16x16x32_bf16 v[92:95], v[236:239], a[212:215], v[92:95]
    ds_read_b64_tr_b16 v[42:43], v58 offset:2048
    buffer_load_dwordx4 v[160:163], v1, s[40:43], s62 offen offset:0 sc1
    v_mfma_f32_16x16x32_bf16 v[96:99], v[236:239], a[216:219], v[96:99]
    ds_read_b64_tr_b16 v[44:45], v59 offset:0
    v_add_f32 v104, v104, v108
    v_mfma_f32_16x16x32_bf16 v[100:103], v[236:239], a[220:223], v[100:103]
    ds_read_b64_tr_b16 v[46:47], v59 offset:2048
    s_waitcnt vmcnt(8)
    v_mfma_f32_16x16x32_bf16 v[72:75], v[128:131], a[0:3], v[24:27]
    ds_read_b64_tr_b16 a[224:225], v58 offset:3584
    v_add_f32 v105, v105, v109
    v_mfma_f32_16x16x32_bf16 v[80:83], v[128:131], a[4:7], 0
    ds_read_b64_tr_b16 a[226:227], v58 offset:5632
    buffer_load_dwordx4 v[164:167], v1, s[40:43], s62 offen offset:1024 sc1
    v_mfma_f32_16x16x32_bf16 v[84:87], v[128:131], a[8:11], 0
    ds_read_b64_tr_b16 a[228:229], v59 offset:3584
    v_add_f32 v106, v106, v110
    v_mfma_f32_16x16x32_bf16 v[88:91], v[128:131], a[12:15], 0
    ds_read_b64_tr_b16 a[230:231], v59 offset:5632
    s_waitcnt vmcnt(8)
    v_mfma_f32_16x16x32_bf16 v[72:75], v[132:135], a[16:19], v[72:75]
    ds_read_b64_tr_b16 a[232:233], v56 offset:3584
    v_add_f32 v107, v107, v111
    v_mfma_f32_16x16x32_bf16 v[80:83], v[132:135], a[20:23], v[80:83]
    ds_read_b64_tr_b16 a[234:235], v56 offset:5632
    buffer_load_dwordx4 v[168:171], v1, s[40:43], s62 offen offset:2048 sc1
    v_mfma_f32_16x16x32_bf16 v[84:87], v[132:135], a[24:27], v[84:87]
    ds_read_b64_tr_b16 a[236:237], v57 offset:3584
    v_add_f32 v64, v64, v112
    v_mfma_f32_16x16x32_bf16 v[88:91], v[132:135], a[28:31], v[88:91]
    ds_read_b64_tr_b16 a[238:239], v57 offset:5632
    s_waitcnt vmcnt(8)
    v_mfma_f32_16x16x32_bf16 v[72:75], v[136:139], a[32:35], v[72:75]
    ds_read_b64_tr_b16 a[240:241], v56 offset:7168
    v_add_f32 v65, v65, v113
    v_mfma_f32_16x16x32_bf16 v[80:83], v[136:139], a[36:39], v[80:83]
    ds_read_b64_tr_b16 a[242:243], v56 offset:9216
    buffer_load_dwordx4 v[172:175], v1, s[40:43], s62 offen offset:3072 sc1
    v_mfma_f32_16x16x32_bf16 v[84:87], v[136:139], a[40:43], v[84:87]
    ds_read_b64_tr_b16 a[244:245], v57 offset:7168
    s_add_u32 s62, s68, 126976
    v_mfma_f32_16x16x32_bf16 v[88:91], v[136:139], a[44:47], v[88:91]
    ds_read_b64_tr_b16 a[246:247], v57 offset:9216
    s_waitcnt vmcnt(8)
    v_mfma_f32_16x16x32_bf16 v[72:75], v[140:143], a[48:51], v[72:75]
    ds_read_b64_tr_b16 a[248:249], v58 offset:7168
    ds_write_b128 v120, v[92:95] offset:5120
    buffer_load_dwordx4 v[176:179], v1, s[40:43], s62 offen offset:0 sc1
    v_mfma_f32_16x16x32_bf16 v[80:83], v[140:143], a[52:55], v[80:83]
    ds_read_b64_tr_b16 a[250:251], v58 offset:9216
    v_add_f32 v66, v66, v114
    v_mfma_f32_16x16x32_bf16 v[84:87], v[140:143], a[56:59], v[84:87]
    ds_read_b64_tr_b16 a[252:253], v59 offset:7168
    v_add_f32 v67, v67, v115
    v_mfma_f32_16x16x32_bf16 v[88:91], v[140:143], a[60:63], v[88:91]
    ds_read_b64_tr_b16 a[254:255], v59 offset:9216
    s_waitcnt vmcnt(8)
    v_mfma_f32_16x16x32_bf16 v[72:75], v[144:147], a[64:67], v[72:75]
    ds_write_b128 v120, v[96:99] offset:9216
    buffer_load_dwordx4 v[180:183], v1, s[40:43], s62 offen offset:1024 sc1
    v_mfma_f32_16x16x32_bf16 v[80:83], v[144:147], a[68:71], v[80:83]
    s_add_u32 s62, s68, 172032
    v_add_f32 v64, v64, v104
    v_mfma_f32_16x16x32_bf16 v[84:87], v[144:147], a[72:75], v[84:87]
    v_add_f32 v65, v65, v105
    v_add_f32 v66, v66, v106
    v_mfma_f32_16x16x32_bf16 v[88:91], v[144:147], a[76:79], v[88:91]
    s_waitcnt vmcnt(8)
    v_add_f32 v67, v67, v107
    v_mfma_f32_16x16x32_bf16 v[72:75], v[148:151], a[80:83], v[72:75]
    ds_write_b128 v120, v[100:103] offset:13312
    buffer_load_dwordx4 v[184:187], v1, s[40:43], s62 offen offset:0 sc1
    v_mfma_f32_16x16x32_bf16 v[80:83], v[148:151], a[84:87], v[80:83]
    v_mul_f32 v116, s76, v64
    v_mul_f32 v117, s76, v65
    v_mfma_f32_16x16x32_bf16 v[84:87], v[148:151], a[88:91], v[84:87]
    v_mul_f32 v118, s76, v66
    v_mul_f32 v119, s76, v67
    v_mfma_f32_16x16x32_bf16 v[88:91], v[148:151], a[92:95], v[88:91]
    s_waitcnt vmcnt(8)
    v_exp_f32 v116, v116
    v_mfma_f32_16x16x32_bf16 v[72:75], v[152:155], a[96:99], v[72:75]
    buffer_load_dwordx4 v[188:191], v1, s[40:43], s62 offen offset:1024 sc1
    v_exp_f32 v117, v117
    v_mfma_f32_16x16x32_bf16 v[80:83], v[152:155], a[100:103], v[80:83]
    v_exp_f32 v118, v118
    v_mfma_f32_16x16x32_bf16 v[84:87], v[152:155], a[104:107], v[84:87]
    v_exp_f32 v119, v119
    v_mfma_f32_16x16x32_bf16 v[88:91], v[152:155], a[108:111], v[88:91]
    v_add_f32 v116, 1.0, v116
    v_add_f32 v117, 1.0, v117
    v_add_f32 v118, 1.0, v118
    v_add_f32 v119, 1.0, v119
    buffer_load_dwordx4 v[192:195], v1, s[40:43], s62 offen offset:2048 sc1
    v_rcp_f32 v116, v116
    v_rcp_f32 v117, v117
    v_rcp_f32 v118, v118
    v_rcp_f32 v119, v119
    v_mul_f32 v64, v64, v116
    v_mul_f32 v65, v65, v117
    v_mul_f32 v66, v66, v118
    v_mul_f32 v67, v67, v119
    s_waitcnt lgkmcnt(0)
    s_barrier
    buffer_load_dwordx4 v[196:199], v1, s[40:43], s62 offen offset:3072 sc1
    s_waitcnt vmcnt(10)
    v_mfma_f32_16x16x32_bf16 v[72:75], v[156:159], a[112:115], v[72:75]
    ds_read_b128 v[104:107], v121 offset:5120
    v_mfma_f32_16x16x32_bf16 v[80:83], v[156:159], a[116:119], v[80:83]
    ds_read_b128 v[108:111], v122 offset:9216
    v_mfma_f32_16x16x32_bf16 v[84:87], v[156:159], a[120:123], v[84:87]
    ds_read_b128 v[112:115], v123 offset:13312
    v_mfma_f32_16x16x32_bf16 v[88:91], v[156:159], a[124:127], v[88:91]
    s_waitcnt vmcnt(9)
    buffer_load_dword v63, v127, s[40:43], 0 offen sc1
    v_mfma_f32_16x16x32_bf16 v[72:75], v[160:163], a[128:131], v[72:75]
    s_add_u32 s62, s68, 176128
    v_mfma_f32_16x16x32_bf16 v[80:83], v[160:163], a[132:135], v[80:83]
    v_mfma_f32_16x16x32_bf16 v[84:87], v[160:163], a[136:139], v[84:87]
    v_mfma_f32_16x16x32_bf16 v[88:91], v[160:163], a[140:143], v[88:91]
    s_waitcnt vmcnt(9)
    buffer_load_dwordx4 v[200:203], v1, s[40:43], s62 offen offset:0 sc1
    v_mfma_f32_16x16x32_bf16 v[72:75], v[164:167], a[144:147], v[72:75]
    s_waitcnt lgkmcnt(0)
    v_add_f32 v104, v104, v108
    v_mfma_f32_16x16x32_bf16 v[80:83], v[164:167], a[148:151], v[80:83]
    v_add_f32 v105, v105, v109
    v_add_f32 v106, v106, v110
    v_mfma_f32_16x16x32_bf16 v[84:87], v[164:167], a[152:155], v[84:87]
    v_add_f32 v107, v107, v111
    v_add_f32 v68, v68, v112
    v_mfma_f32_16x16x32_bf16 v[88:91], v[164:167], a[156:159], v[88:91]
    s_waitcnt vmcnt(9)
    buffer_load_dwordx4 v[204:207], v1, s[40:43], s62 offen offset:1024 sc1
    v_mfma_f32_16x16x32_bf16 v[72:75], v[168:171], a[160:163], v[72:75]
    v_add_f32 v69, v69, v113
    v_add_f32 v70, v70, v114
    v_mfma_f32_16x16x32_bf16 v[80:83], v[168:171], a[164:167], v[80:83]
    v_add_f32 v71, v71, v115
    v_add_f32 v68, v68, v104
    v_mfma_f32_16x16x32_bf16 v[84:87], v[168:171], a[168:171], v[84:87]
    v_add_f32 v69, v69, v105
    v_add_f32 v70, v70, v106
    v_mfma_f32_16x16x32_bf16 v[88:91], v[168:171], a[172:175], v[88:91]
    s_waitcnt vmcnt(9)
    buffer_load_dwordx4 v[208:211], v1, s[40:43], s62 offen offset:2048 sc1
    v_mfma_f32_16x16x32_bf16 v[72:75], v[172:175], a[176:179], v[72:75]
    v_add_f32 v71, v71, v107
    v_mul_f32 v116, s76, v68
    v_mfma_f32_16x16x32_bf16 v[80:83], v[172:175], a[180:183], v[80:83]
    v_mul_f32 v117, s76, v69
    v_mul_f32 v118, s76, v70
    v_mfma_f32_16x16x32_bf16 v[84:87], v[172:175], a[184:187], v[84:87]
    v_mul_f32 v119, s76, v71
    v_exp_f32 v116, v116
    v_mfma_f32_16x16x32_bf16 v[88:91], v[172:175], a[188:191], v[88:91]
    s_waitcnt vmcnt(9)
    buffer_load_dwordx4 v[212:215], v1, s[40:43], s62 offen offset:3072 sc1
    v_mfma_f32_16x16x32_bf16 v[72:75], v[176:179], a[192:195], v[72:75]
    s_add_u32 s62, s68, 180224
    v_exp_f32 v117, v117
    v_mfma_f32_16x16x32_bf16 v[80:83], v[176:179], a[196:199], v[80:83]
    v_exp_f32 v118, v118
    v_mfma_f32_16x16x32_bf16 v[84:87], v[176:179], a[200:203], v[84:87]
    v_exp_f32 v119, v119
    v_mfma_f32_16x16x32_bf16 v[88:91], v[176:179], a[204:207], v[88:91]
    s_waitcnt vmcnt(9)
    buffer_load_dwordx4 v[216:219], v1, s[40:43], s62 offen offset:0 sc1
    v_mfma_f32_16x16x32_bf16 v[72:75], v[180:183], a[208:211], v[72:75]
    v_add_f32 v116, 1.0, v116
    v_add_f32 v117, 1.0, v117
    v_mfma_f32_16x16x32_bf16 v[80:83], v[180:183], a[212:215], v[80:83]
    v_add_f32 v118, 1.0, v118
    v_add_f32 v119, 1.0, v119
    v_mfma_f32_16x16x32_bf16 v[84:87], v[180:183], a[216:219], v[84:87]
    v_rcp_f32 v116, v116
    v_mfma_f32_16x16x32_bf16 v[88:91], v[180:183], a[220:223], v[88:91]
    s_waitcnt vmcnt(9)
    buffer_load_dwordx4 v[220:223], v1, s[40:43], s62 offen offset:1024 sc1
    v_mfma_f32_16x16x32_bf16 v[76:79], v[184:187], a[0:3], v[24:27]
    v_rcp_f32 v117, v117
    v_mfma_f32_16x16x32_bf16 v[92:95], v[184:187], a[4:7], 0
    v_rcp_f32 v118, v118
    v_mfma_f32_16x16x32_bf16 v[96:99], v[184:187], a[8:11], 0
    v_rcp_f32 v119, v119
    v_mfma_f32_16x16x32_bf16 v[100:103], v[184:187], a[12:15], 0
    s_waitcnt vmcnt(9)
    buffer_load_dwordx4 v[224:227], v1, s[40:43], s62 offen offset:2048 sc1
    v_mfma_f32_16x16x32_bf16 v[76:79], v[188:191], a[16:19], v[76:79]
    ds_read_b64_tr_b16 v[16:17], v58 offset:10752
    ds_write_b128 v120, v[80:83] offset:6144
    v_mfma_f32_16x16x32_bf16 v[92:95], v[188:191], a[20:23], v[92:95]
    ds_read_b64_tr_b16 v[18:19], v58 offset:12800
    buffer_load_dwordx4 v[228:231], v1, s[40:43], s62 offen offset:3072 sc1
    v_mfma_f32_16x16x32_bf16 v[96:99], v[188:191], a[24:27], v[96:99]
    ds_read_b64_tr_b16 v[20:21], v59 offset:10752
    s_add_u32 s62, s68, 184320
    v_mfma_f32_16x16x32_bf16 v[100:103], v[188:191], a[28:31], v[100:103]
    ds_read_b64_tr_b16 v[22:23], v59 offset:12800
    s_waitcnt vmcnt(10)
    v_mfma_f32_16x16x32_bf16 v[76:79], v[192:195], a[32:35], v[76:79]
    ds_read_b64_tr_b16 v[24:25], v56 offset:10752
    ds_write_b128 v120, v[84:87] offset:10240
    buffer_load_dwordx4 v[232:235], v1, s[40:43], s62 offen offset:0 sc1
    v_mfma_f32_16x16x32_bf16 v[92:95], v[192:195], a[36:39], v[92:95]
    ds_read_b64_tr_b16 v[26:27], v56 offset:12800
    v_mul_f32 v68, v68, v116
    v_mfma_f32_16x16x32_bf16 v[96:99], v[192:195], a[40:43], v[96:99]
    ds_read_b64_tr_b16 v[28:29], v57 offset:10752
    v_mul_f32 v69, v69, v117
    v_mfma_f32_16x16x32_bf16 v[100:103], v[192:195], a[44:47], v[100:103]
    ds_read_b64_tr_b16 v[30:31], v57 offset:12800
    s_waitcnt vmcnt(10)
    v_mfma_f32_16x16x32_bf16 v[76:79], v[196:199], a[48:51], v[76:79]
    ds_read_b64_tr_b16 a[0:1], v56 offset:14336
    ds_write_b128 v120, v[88:91] offset:14336
    buffer_load_dwordx4 v[236:239], v1, s[40:43], s62 offen offset:1024 sc1
    v_mfma_f32_16x16x32_bf16 v[92:95], v[196:199], a[52:55], v[92:95]
    ds_read_b64_tr_b16 a[2:3], v56 offset:16384
    s_waitcnt vmcnt(10)
    v_cmp_eq_u32 vcc, 0, v63
    s_nop 4
    s_cbranch_vccnz L_spin_24
L_go_25:
    v_mfma_f32_16x16x32_bf16 v[96:99], v[196:199], a[56:59], v[96:99]
    ds_read_b64_tr_b16 a[4:5], v57 offset:14336
    s_add_u32 s62, s47, 0
    v_mfma_f32_16x16x32_bf16 v[100:103], v[196:199], a[60:63], v[100:103]
    ds_read_b64_tr_b16 a[6:7], v57 offset:16384
    s_waitcnt vmcnt(9)
    v_mfma_f32_16x16x32_bf16 v[76:79], v[200:203], a[64:67], v[76:79]
    buffer_load_dwordx4 v[128:131], v1, s[40:43], s62 offen offset:0 sc1
    ds_read_b64_tr_b16 a[8:9], v58 offset:14336
    v_mfma_f32_16x16x32_bf16 v[92:95], v[200:203], a[68:71], v[92:95]
    ds_read_b64_tr_b16 a[10:11], v58 offset:16384
    v_mul_f32 v70, v70, v118
    v_mfma_f32_16x16x32_bf16 v[96:99], v[200:203], a[72:75], v[96:99]
    ds_read_b64_tr_b16 a[12:13], v59 offset:14336
    v_mul_f32 v71, v71, v119
    v_mfma_f32_16x16x32_bf16 v[100:103], v[200:203], a[76:79], v[100:103]
    ds_read_b64_tr_b16 a[14:15], v59 offset:16384
    s_waitcnt lgkmcnt(7)
    s_barrier
    buffer_load_dwordx4 v[132:135], v1, s[40:43], s62 offen offset:1024 sc1
    s_waitcnt vmcnt(10)
    v_mfma_f32_16x16x32_bf16 v[76:79], v[204:207], a[80:83], v[76:79]
    ds_read_b64_tr_b16 a[16:17], v58 offset:17920
    ds_read_b128 v[104:107], v121 offset:6144
    v_mfma_f32_16x16x32_bf16 v[92:95], v[204:207], a[84:87], v[92:95]
    ds_read_b64_tr_b16 a[18:19], v58 offset:19968
    ds_read_b128 v[108:111], v122 offset:10240
    v_mfma_f32_16x16x32_bf16 v[96:99], v[204:207], a[88:91], v[96:99]
    ds_read_b64_tr_b16 a[20:21], v59 offset:17920
    ds_read_b128 v[112:115], v123 offset:14336
    v_mfma_f32_16x16x32_bf16 v[100:103], v[204:207], a[92:95], v[100:103]
    ds_read_b64_tr_b16 a[22:23], v59 offset:19968
    buffer_load_dwordx4 v[136:139], v1, s[40:43], s62 offen offset:2048 sc1
    s_waitcnt vmcnt(10)
    v_mfma_f32_16x16x32_bf16 v[76:79], v[208:211], a[96:99], v[76:79]
    ds_read_b64_tr_b16 a[24:25], v56 offset:17920
    v_mfma_f32_16x16x32_bf16 v[92:95], v[208:211], a[100:103], v[92:95]
    ds_read_b64_tr_b16 a[26:27], v56 offset:19968
    v_mfma_f32_16x16x32_bf16 v[96:99], v[208:211], a[104:107], v[96:99]
    ds_read_b64_tr_b16 a[28:29], v57 offset:17920
    v_mfma_f32_16x16x32_bf16 v[100:103], v[208:211], a[108:111], v[100:103]
    ds_read_b64_tr_b16 a[30:31], v57 offset:19968
    buffer_load_dwordx4 v[140:143], v1, s[40:43], s62 offen offset:3072 sc1
    s_waitcnt vmcnt(10)
    v_mfma_f32_16x16x32_bf16 v[76:79], v[212:215], a[112:115], v[76:79]
    ds_read_b64_tr_b16 a[32:33], v56 offset:21504
    s_add_u32 s62, s47, 4096
    v_mfma_f32_16x16x32_bf16 v[92:95], v[212:215], a[116:119], v[92:95]
    ds_read_b64_tr_b16 a[34:35], v56 offset:23552
    s_waitcnt lgkmcnt(7)
    v_mfma_f32_16x16x32_bf16 v[96:99], v[212:215], a[120:123], v[96:99]
    ds_read_b64_tr_b16 a[36:37], v57 offset:21504
    v_add_f32 v104, v104, v108
    v_mfma_f32_16x16x32_bf16 v[100:103], v[212:215], a[124:127], v[100:103]
    ds_read_b64_tr_b16 a[38:39], v57 offset:23552
    buffer_load_dwordx4 v[144:147], v1, s[40:43], s62 offen offset:0 sc1
    s_waitcnt vmcnt(10)
    v_mfma_f32_16x16x32_bf16 v[76:79], v[216:219], a[128:131], v[76:79]
    ds_read_b64_tr_b16 a[40:41], v58 offset:21504
    v_add_f32 v105, v105, v109
    v_mfma_f32_16x16x32_bf16 v[92:95], v[216:219], a[132:135], v[92:95]
    ds_read_b64_tr_b16 a[42:43], v58 offset:23552
    v_add_f32 v106, v106, v110
    v_mfma_f32_16x16x32_bf16 v[96:99], v[216:219], a[136:139], v[96:99]
    ds_read_b64_tr_b16 a[44:45], v59 offset:21504
    v_add_f32 v107, v107, v111
    v_mfma_f32_16x16x32_bf16 v[100:103], v[216:219], a[140:143], v[100:103]
    ds_read_b64_tr_b16 a[46:47], v59 offset:23552
    buffer_load_dwordx4 v[148:151], v1, s[40:43], s62 offen offset:1024 sc1
    s_waitcnt vmcnt(10)
    v_mfma_f32_16x16x32_bf16 v[76:79], v[220:223], a[144:147], v[76:79]
    ds_read_b64_tr_b16 a[48:49], v58 offset:25088
    v_add_f32 v72, v72, v112
    v_mfma_f32_16x16x32_bf16 v[92:95], v[220:223], a[148:151], v[92:95]
    ds_read_b64_tr_b16 a[50:51], v58 offset:27136
    v_add_f32 v73, v73, v113
    v_mfma_f32_16x16x32_bf16 v[96:99], v[220:223], a[152:155], v[96:99]
    ds_read_b64_tr_b16 a[52:53], v59 offset:25088
    v_add_f32 v74, v74, v114
    v_mfma_f32_16x16x32_bf16 v[100:103], v[220:223], a[156:159], v[100:103]
    ds_read_b64_tr_b16 a[54:55], v59 offset:27136
    buffer_load_dwordx4 v[48:51], v0, s[4:7], s56 offen
    s_waitcnt vmcnt(10)
    v_mfma_f32_16x16x32_bf16 v[76:79], v[224:227], a[160:163], v[76:79]
    ds_read_b64_tr_b16 a[56:57], v56 offset:25088
    s_add_u32 s61, s56, 7168
    v_mfma_f32_16x16x32_bf16 v[92:95], v[224:227], a[164:167], v[92:95]
    ds_read_b64_tr_b16 a[58:59], v56 offset:27136
    v_add_f32 v75, v75, v115
    v_mfma_f32_16x16x32_bf16 v[96:99], v[224:227], a[168:171], v[96:99]
    ds_read_b64_tr_b16 a[60:61], v57 offset:25088
    v_add_f32 v72, v72, v104
    v_mfma_f32_16x16x32_bf16 v[100:103], v[224:227], a[172:175], v[100:103]
    ds_read_b64_tr_b16 a[62:63], v57 offset:27136
    buffer_load_dwordx4 v[52:55], v0, s[4:7], s61 offen
    s_waitcnt vmcnt(10)
    v_mfma_f32_16x16x32_bf16 v[76:79], v[228:231], a[176:179], v[76:79]
    ds_read_b64_tr_b16 a[64:65], v56 offset:28672
    v_add_f32 v73, v73, v105
    v_mfma_f32_16x16x32_bf16 v[92:95], v[228:231], a[180:183], v[92:95]
    ds_read_b64_tr_b16 a[66:67], v56 offset:30720
    v_add_f32 v74, v74, v106
    v_mfma_f32_16x16x32_bf16 v[96:99], v[228:231], a[184:187], v[96:99]
    ds_read_b64_tr_b16 a[68:69], v57 offset:28672
    v_add_f32 v75, v75, v107
    v_mfma_f32_16x16x32_bf16 v[100:103], v[228:231], a[188:191], v[100:103]
    ds_read_b64_tr_b16 a[70:71], v57 offset:30720
    buffer_load_dwordx4 v[152:155], v1, s[40:43], s62 offen offset:2048 sc1
    s_waitcnt vmcnt(10)
    v_mfma_f32_16x16x32_bf16 v[76:79], v[232:235], a[192:195], v[76:79]
    ds_read_b64_tr_b16 a[72:73], v58 offset:28672
    v_mul_f32 v116, s76, v72
    v_mfma_f32_16x16x32_bf16 v[92:95], v[232:235], a[196:199], v[92:95]
    ds_read_b64_tr_b16 a[74:75], v58 offset:30720
    v_mul_f32 v117, s76, v73
    v_mfma_f32_16x16x32_bf16 v[96:99], v[232:235], a[200:203], v[96:99]
    ds_read_b64_tr_b16 a[76:77], v59 offset:28672
    v_mul_f32 v118, s76, v74
    v_mfma_f32_16x16x32_bf16 v[100:103], v[232:235], a[204:207], v[100:103]
    ds_read_b64_tr_b16 a[78:79], v59 offset:30720
    buffer_load_dwordx4 v[156:159], v1, s[40:43], s62 offen offset:3072 sc1
    s_waitcnt vmcnt(10)
    v_mfma_f32_16x16x32_bf16 v[76:79], v[236:239], a[208:211], v[76:79]
    ds_read_b64_tr_b16 a[80:81], v58 offset:32256
    s_add_u32 s62, s47, 8192
    v_mfma_f32_16x16x32_bf16 v[92:95], v[236:239], a[212:215], v[92:95]
    ds_read_b64_tr_b16 a[82:83], v58 offset:34304
    v_mul_f32 v119, s76, v75
    v_mfma_f32_16x16x32_bf16 v[96:99], v[236:239], a[216:219], v[96:99]
    ds_read_b64_tr_b16 a[84:85], v59 offset:32256
    v_exp_f32 v116, v116
    v_mfma_f32_16x16x32_bf16 v[100:103], v[236:239], a[220:223], v[100:103]
    buffer_load_dwordx4 v[160:163], v1, s[40:43], s62 offen offset:0 sc1
    ds_read_b64_tr_b16 a[86:87], v59 offset:34304
    s_waitcnt vmcnt(10)
    v_mfma_f32_16x16x32_bf16 v[240:243], v[32:35], v[128:131], 0
    ds_read_b64_tr_b16 a[88:89], v56 offset:32256
    v_exp_f32 v117, v117
    v_mfma_f32_16x16x32_bf16 v[244:247], v[36:39], v[128:131], 0
    ds_read_b64_tr_b16 a[90:91], v56 offset:34304
    v_exp_f32 v118, v118
    v_mfma_f32_16x16x32_bf16 v[248:251], v[40:43], v[128:131], 0
    ds_read_b64_tr_b16 a[92:93], v57 offset:32256
    v_exp_f32 v119, v119
    v_mfma_f32_16x16x32_bf16 v[252:255], v[44:47], v[128:131], 0
    buffer_load_dwordx4 v[164:167], v1, s[40:43], s62 offen offset:1024 sc1
    ds_read_b64_tr_b16 a[94:95], v57 offset:34304
    v_add_f32 v116, 1.0, v116
    s_waitcnt vmcnt(10)
    v_mfma_f32_16x16x32_bf16 v[240:243], a[224:227], v[132:135], v[240:243]
    ds_read_b64_tr_b16 a[96:97], v56 offset:35840
    ds_write_b128 v120, v[92:95] offset:7168
    buffer_load_dwordx4 v[168:171], v1, s[40:43], s62 offen offset:2048 sc1
    v_add_f32 v117, 1.0, v117
    v_mfma_f32_16x16x32_bf16 v[244:247], a[228:231], v[132:135], v[244:247]
    ds_read_b64_tr_b16 a[98:99], v56 offset:37888
    v_add_f32 v118, 1.0, v118
    v_mfma_f32_16x16x32_bf16 v[248:251], a[232:235], v[132:135], v[248:251]
    ds_read_b64_tr_b16 a[100:101], v57 offset:35840
    v_add_f32 v119, 1.0, v119
    v_mfma_f32_16x16x32_bf16 v[252:255], a[236:239], v[132:135], v[252:255]
    ds_read_b64_tr_b16 a[102:103], v57 offset:37888
    v_rcp_f32 v116, v116
    s_waitcnt vmcnt(10)
    v_mfma_f32_16x16x32_bf16 v[240:243], a[240:243], v[136:139], v[240:243]
    buffer_load_dwordx4 v[172:175], v1, s[40:43], s62 offen offset:3072 sc1
    ds_read_b64_tr_b16 a[104:105], v58 offset:35840
    ds_write_b128 v120, v[96:99] offset:11264
    v_rcp_f32 v117, v117
    v_mfma_f32_16x16x32_bf16 v[244:247], a[244:247], v[136:139], v[244:247]
    s_add_u32 s62, s47, 12288
    buffer_load_dwordx4 v[176:179], v1, s[40:43], s62 offen offset:0 sc1
    ds_read_b64_tr_b16 a[106:107], v58 offset:37888
    v_rcp_f32 v118, v118
    v_mfma_f32_16x16x32_bf16 v[248:251], a[248:251], v[136:139], v[248:251]
    ds_read_b64_tr_b16 a[108:109], v59 offset:35840
    v_rcp_f32 v119, v119
    v_mfma_f32_16x16x32_bf16 v[252:255], a[252:255], v[136:139], v[252:255]
    ds_read_b64_tr_b16 a[110:111], v59 offset:37888
    v_mul_f32 v72, v72, v116
    s_waitcnt vmcnt(11)
    v_mfma_f32_16x16x32_bf16 v[240:243], v[16:19], v[140:143], v[240:243]
    ds_read_b64_tr_b16 a[112:113], v58 offset:39424
    buffer_load_dwordx4 v[180:183], v1, s[40:43], s62 offen offset:1024 sc1
    ds_write_b128 v120, v[100:103] offset:15360
    v_mul_f32 v73, v73, v117
    v_mfma_f32_16x16x32_bf16 v[244:247], v[20:23], v[140:143], v[244:247]
    ds_read_b64_tr_b16 a[114:115], v58 offset:41472
    v_mul_f32 v74, v74, v118
    v_mfma_f32_16x16x32_bf16 v[248:251], v[24:27], v[140:143], v[248:251]
    buffer_load_dwordx4 v[184:187], v1, s[40:43], s62 offen offset:2048 sc1
    ds_read_b64_tr_b16 a[116:117], v59 offset:39424
    v_mul_f32 v75, v75, v119
    v_mfma_f32_16x16x32_bf16 v[252:255], v[28:31], v[140:143], v[252:255]
    ds_read_b64_tr_b16 a[118:119], v59 offset:41472
    s_waitcnt vmcnt(12)
    v_mfma_f32_16x16x32_bf16 v[240:243], a[0:3], v[144:147], v[240:243]
    ds_read_b64_tr_b16 a[120:121], v56 offset:39424
    v_mfma_f32_16x16x32_bf16 v[244:247], a[4:7], v[144:147], v[244:247]
    ds_read_b64_tr_b16 a[122:123], v56 offset:41472
    v_mfma_f32_16x16x32_bf16 v[248:251], a[8:11], v[144:147], v[248:251]
    buffer_load_dwordx4 v[188:191], v1, s[40:43], s62 offen offset:3072 sc1
    ds_read_b64_tr_b16 a[124:125], v57 offset:39424
    v_mfma_f32_16x16x32_bf16 v[252:255], a[12:15], v[144:147], v[252:255]
    ds_read_b64_tr_b16 a[126:127], v57 offset:41472
    s_waitcnt lgkmcnt(7)
    s_barrier
    s_waitcnt vmcnt(12)
    v_mfma_f32_16x16x32_bf16 v[240:243], a[16:19], v[148:151], v[240:243]
    ds_read_b64_tr_b16 a[128:129], v56 offset:43008
    ds_read_b128 v[104:107], v121 offset:7168
    v_mfma_f32_16x16x32_bf16 v[244:247], a[20:23], v[148:151], v[244:247]
    ds_read_b64_tr_b16 a[130:131], v56 offset:45056
    ds_read_b128 v[108:111], v122 offset:11264
    v_mfma_f32_16x16x32_bf16 v[248:251], a[24:27], v[148:151], v[248:251]
    ds_read_b64_tr_b16 a[132:133], v57 offset:43008
    ds_read_b128 v[112:115], v123 offset:15360
    v_mfma_f32_16x16x32_bf16 v[252:255], a[28:31], v[148:151], v[252:255]
    ds_read_b64_tr_b16 a[134:135], v57 offset:45056
    s_waitcnt vmcnt(10)
    ds_write_b128 v10, v[48:51] offset:0
    ds_write_b128 v10, v[52:55] offset:1152
    ds_read_b64 v[48:49], v11 offset:0
    ds_read_b64 v[50:51], v11 offset:32
    ds_read_b64 v[52:53], v11 offset:64
    ds_read_b64 v[54:55], v11 offset:96
    s_waitcnt vmcnt(9)
    v_mfma_f32_16x16x32_bf16 v[240:243], a[32:35], v[152:155], v[240:243]
    ds_read_b64_tr_b16 a[136:137], v58 offset:43008
    v_mfma_f32_16x16x32_bf16 v[244:247], a[36:39], v[152:155], v[244:247]
    ds_read_b64_tr_b16 a[138:139], v58 offset:45056
    v_mfma_f32_16x16x32_bf16 v[248:251], a[40:43], v[152:155], v[248:251]
    ds_read_b64_tr_b16 a[140:141], v59 offset:43008
    v_mfma_f32_16x16x32_bf16 v[252:255], a[44:47], v[152:155], v[252:255]
    ds_read_b64_tr_b16 a[142:143], v59 offset:45056
    s_waitcnt vmcnt(8)
    v_mfma_f32_16x16x32_bf16 v[240:243], a[48:51], v[156:159], v[240:243]
    ds_read_b64_tr_b16 a[144:145], v58 offset:46592
    s_waitcnt lgkmcnt(12)
    v_mfma_f32_16x16x32_bf16 v[244:247], a[52:55], v[156:159], v[244:247]
    ds_read_b64_tr_b16 a[146:147], v58 offset:48640
    v_add_f32 v104, v104, v108
    v_mfma_f32_16x16x32_bf16 v[248:251], a[56:59], v[156:159], v[248:251]
    ds_read_b64_tr_b16 a[148:149], v59 offset:46592
    v_add_f32 v105, v105, v109
    v_mfma_f32_16x16x32_bf16 v[252:255], a[60:63], v[156:159], v[252:255]
    ds_read_b64_tr_b16 a[150:151], v59 offset:48640
    v_add_f32 v106, v106, v110
    s_waitcnt vmcnt(7)
    v_mfma_f32_16x16x32_bf16 v[240:243], a[64:67], v[160:163], v[240:243]
    ds_read_b64_tr_b16 a[152:153], v56 offset:46592
    v_add_f32 v107, v107, v111
    v_mfma_f32_16x16x32_bf16 v[244:247], a[68:71], v[160:163], v[244:247]
    ds_read_b64_tr_b16 a[154:155], v56 offset:48640
    v_add_f32 v76, v76, v112
    v_mfma_f32_16x16x32_bf16 v[248:251], a[72:75], v[160:163], v[248:251]
    ds_read_b64_tr_b16 a[156:157], v57 offset:46592
    v_add_f32 v77, v77, v113
    v_mfma_f32_16x16x32_bf16 v[252:255], a[76:79], v[160:163], v[252:255]
    ds_read_b64_tr_b16 a[158:159], v57 offset:48640
    v_add_f32 v78, v78, v114
    s_waitcnt vmcnt(6)
    v_mfma_f32_16x16x32_bf16 v[240:243], a[80:83], v[164:167], v[240:243]
    ds_read_b64_tr_b16 a[160:161], v56 offset:50176
    v_add_f32 v79, v79, v115
    v_mfma_f32_16x16x32_bf16 v[244:247], a[84:87], v[164:167], v[244:247]
    ds_read_b64_tr_b16 a[162:163], v56 offset:52224
    v_add_f32 v76, v76, v104
    v_mfma_f32_16x16x32_bf16 v[248:251], a[88:91], v[164:167], v[248:251]
    ds_read_b64_tr_b16 a[164:165], v57 offset:50176
    v_add_f32 v77, v77, v105
    v_mfma_f32_16x16x32_bf16 v[252:255], a[92:95], v[164:167], v[252:255]
    ds_read_b64_tr_b16 a[166:167], v57 offset:52224
    v_add_f32 v78, v78, v106
    s_waitcnt vmcnt(5)
    v_mfma_f32_16x16x32_bf16 v[240:243], a[96:99], v[168:171], v[240:243]
    ds_read_b64_tr_b16 a[168:169], v58 offset:50176
    v_add_f32 v79, v79, v107
    v_mfma_f32_16x16x32_bf16 v[244:247], a[100:103], v[168:171], v[244:247]
    ds_read_b64_tr_b16 a[170:171], v58 offset:52224
    v_mul_f32 v116, s76, v76
    v_mfma_f32_16x16x32_bf16 v[248:251], a[104:107], v[168:171], v[248:251]
    ds_read_b64_tr_b16 a[172:173], v59 offset:50176
    v_mul_f32 v117, s76, v77
    v_mfma_f32_16x16x32_bf16 v[252:255], a[108:111], v[168:171], v[252:255]
    ds_read_b64_tr_b16 a[174:175], v59 offset:52224
    v_mul_f32 v118, s76, v78
    s_waitcnt vmcnt(4)
    v_mfma_f32_16x16x32_bf16 v[240:243], a[112:115], v[172:175], v[240:243]
    ds_read_b64_tr_b16 a[176:177], v58 offset:53760
    v_mul_f32 v119, s76, v79
    v_mfma_f32_16x16x32_bf16 v[244:247], a[116:119], v[172:175], v[244:247]
    ds_read_b64_tr_b16 a[178:179], v58 offset:55808
    v_exp_f32 v116, v116
    v_mfma_f32_16x16x32_bf16 v[248:251], a[120:123], v[172:175], v[248:251]
    ds_read_b64_tr_b16 a[180:181], v59 offset:53760
    v_exp_f32 v117, v117
    v_mfma_f32_16x16x32_bf16 v[252:255], a[124:127], v[172:175], v[252:255]
    ds_read_b64_tr_b16 a[182:183], v59 offset:55808
    v_exp_f32 v118, v118
    s_waitcnt lgkmcnt(15)
    s_waitcnt vmcnt(3)
    v_mfma_f32_16x16x32_bf16 v[240:243], a[128:131], v[176:179], v[240:243]
    ds_read_b64_tr_b16 a[184:185], v56 offset:53760
    v_exp_f32 v119, v119
    v_mfma_f32_16x16x32_bf16 v[244:247], a[132:135], v[176:179], v[244:247]
    ds_read_b64_tr_b16 a[186:187], v56 offset:55808
    v_add_f32 v116, 1.0, v116
    v_mfma_f32_16x16x32_bf16 v[248:251], a[136:139], v[176:179], v[248:251]
    ds_read_b64_tr_b16 a[188:189], v57 offset:53760
    v_add_f32 v117, 1.0, v117
    v_mfma_f32_16x16x32_bf16 v[252:255], a[140:143], v[176:179], v[252:255]
    ds_read_b64_tr_b16 a[190:191], v57 offset:55808
    v_add_f32 v118, 1.0, v118
    v_add_f32 v119, 1.0, v119
    s_waitcnt lgkmcnt(15)
    s_waitcnt vmcnt(2)
    v_mfma_f32_16x16x32_bf16 v[240:243], a[144:147], v[180:183], v[240:243]
    v_rcp_f32 v116, v116
    v_rcp_f32 v117, v117
    v_mfma_f32_16x16x32_bf16 v[244:247], a[148:151], v[180:183], v[244:247]
    v_rcp_f32 v118, v118
    v_rcp_f32 v119, v119
    v_mfma_f32_16x16x32_bf16 v[248:251], a[152:155], v[180:183], v[248:251]
    v_mul_f32 v76, v76, v116
    v_mul_f32 v77, v77, v117
    v_mfma_f32_16x16x32_bf16 v[252:255], a[156:159], v[180:183], v[252:255]
    v_mul_f32 v78, v78, v118
    v_mul_f32 v79, v79, v119
    s_waitcnt lgkmcnt(8)
    s_waitcnt vmcnt(1)
    v_mfma_f32_16x16x32_bf16 v[240:243], a[160:163], v[184:187], v[240:243]
    v_lshlrev_b32 v80, 16, v48
    v_mfma_f32_16x16x32_bf16 v[244:247], a[164:167], v[184:187], v[244:247]
    v_and_b32 v81, 0xffff0000, v48
    v_lshlrev_b32 v82, 16, v49
    v_mfma_f32_16x16x32_bf16 v[248:251], a[168:171], v[184:187], v[248:251]
    v_and_b32 v83, 0xffff0000, v49
    v_lshlrev_b32 v84, 16, v50
    v_mfma_f32_16x16x32_bf16 v[252:255], a[172:175], v[184:187], v[252:255]
    v_and_b32 v85, 0xffff0000, v50
    v_lshlrev_b32 v86, 16, v51
    s_waitcnt lgkmcnt(0)
    s_waitcnt vmcnt(0)
    v_mfma_f32_16x16x32_bf16 v[240:243], a[176:179], v[188:191], v[240:243]
    v_and_b32 v87, 0xffff0000, v51
    v_lshlrev_b32 v88, 16, v52
    v_mfma_f32_16x16x32_bf16 v[244:247], a[180:183], v[188:191], v[244:247]
    v_and_b32 v89, 0xffff0000, v52
    v_lshlrev_b32 v90, 16, v53
    v_mfma_f32_16x16x32_bf16 v[248:251], a[184:187], v[188:191], v[248:251]
    v_and_b32 v91, 0xffff0000, v53
    v_lshlrev_b32 v92, 16, v54
    v_mfma_f32_16x16x32_bf16 v[252:255], a[188:191], v[188:191], v[252:255]
    v_and_b32 v93, 0xffff0000, v54
    v_lshlrev_b32 v94, 16, v55
    v_and_b32 v95, 0xffff0000, v55
    v_pk_fma_f32 v[80:81], v[240:241], v[64:65], v[80:81]
    v_pk_fma_f32 v[82:83], v[242:243], v[66:67], v[82:83]
    v_cvt_pk_bf16_f32 v48, v80, v81
    v_cvt_pk_bf16_f32 v49, v82, v83
    ds_write_b64 v11, v[48:49] offset:0
    v_pk_fma_f32 v[84:85], v[244:245], v[68:69], v[84:85]
    v_pk_fma_f32 v[86:87], v[246:247], v[70:71], v[86:87]
    v_cvt_pk_bf16_f32 v50, v84, v85
    v_cvt_pk_bf16_f32 v51, v86, v87
    ds_write_b64 v11, v[50:51] offset:32
    v_pk_fma_f32 v[88:89], v[248:249], v[72:73], v[88:89]
    v_pk_fma_f32 v[90:91], v[250:251], v[74:75], v[90:91]
    v_cvt_pk_bf16_f32 v52, v88, v89
    v_cvt_pk_bf16_f32 v53, v90, v91
    ds_write_b64 v11, v[52:53] offset:64
    v_pk_fma_f32 v[92:93], v[252:253], v[76:77], v[92:93]
    v_pk_fma_f32 v[94:95], v[254:255], v[78:79], v[94:95]
    v_cvt_pk_bf16_f32 v54, v92, v93
    v_cvt_pk_bf16_f32 v55, v94, v95
    ds_write_b64 v11, v[54:55] offset:96
    ds_read_b128 v[16:19], v10 offset:0
    ds_read_b128 v[20:23], v10 offset:1152
    s_waitcnt lgkmcnt(1)
    buffer_store_dwordx4 v[16:19], v0, s[32:35], s56 offen
    s_waitcnt lgkmcnt(0)
    buffer_store_dwordx4 v[20:23], v0, s[32:35], s61 offen
L_end:
    s_endpgm
L_spin_1:
    s_mov_b32 s65, 0
L_retry_3:
    s_sleep 8
    buffer_load_dwordx4 v[20:23], v15, s[36:39], 0 offen sc1
    s_waitcnt vmcnt(0)
    v_min3_u32 v20, v20, v21, v22
    v_min_u32 v20, v20, v23
    v_cmp_eq_u32 vcc, 0, v20
    s_add_u32 s65, s65, 1
    s_cmp_gt_u32 s65, 0x20000
    s_nop 1
    s_cbranch_scc1 L_go_2
    s_cbranch_vccnz L_retry_3
    s_branch L_go_2
L_spin_4:
    s_mov_b32 s65, 0
L_retry_6:
    s_and_b32 s76, s65, 3
    s_cmp_eq_u32 s76, 0
    s_cbranch_scc0 L_own_7
    s_lshl_b32 s76, s2, 5
    s_mov_b64 exec, 0xff
    buffer_load_dword v24, v36, s[40:43], s76 offen offset:0 sc1
    s_waitcnt vmcnt(0)
    v_cmp_eq_u32 vcc, 0, v24
    s_nop 4
    s_cbranch_vccz L_own_7
    buffer_store_dword v48, v36, s[40:43], s76 offen offset:0 sc1
L_own_7:
    s_mov_b64 exec, -1
    s_sleep 8
    buffer_load_dwordx4 v[24:27], v62, s[40:43], 0 offen offset:0 sc1
    buffer_load_dwordx4 v[28:31], v62, s[40:43], 0 offen offset:1024 sc1
    s_waitcnt vmcnt(0)
    v_min3_u32 v24, v24, v25, v26
    v_min3_u32 v24, v24, v27, v28
    v_min3_u32 v24, v24, v29, v30
    v_min_u32 v24, v24, v31
    v_cmp_eq_u32 vcc, 0, v24
    s_add_u32 s65, s65, 1
    s_cmp_gt_u32 s65, 0x20000
    s_nop 1
    s_cbranch_scc1 L_go_5
    s_cbranch_vccnz L_retry_6
    s_branch L_go_5
L_spin_8:
    s_mov_b32 s65, 0
L_retry_10:
    s_sleep 8
    buffer_load_dword v40, v63, s[40:43], 0 offen sc1
    s_waitcnt vmcnt(0)
    v_or_b32 v40, s44, v40
    v_cmp_eq_u32 vcc, 0, v40
    s_add_u32 s65, s65, 1
    s_cmp_gt_u32 s65, 0x20000
    s_nop 1
    s_cbranch_scc1 L_go_9
    s_cbranch_vccnz L_retry_10
    s_branch L_go_9
L_spin_11:
    s_mov_b32 s65, 0
L_retry_13:
    s_sleep 8
    buffer_load_dwordx4 v[20:23], v15, s[36:39], 0 offen sc1
    s_waitcnt vmcnt(0)
    v_min3_u32 v20, v20, v21, v22
    v_min_u32 v20, v20, v23
    v_cmp_eq_u32 vcc, 0, v20
    s_add_u32 s65, s65, 1
    s_cmp_gt_u32 s65, 0x20000
    s_nop 1
    s_cbranch_scc1 L_go_12
    s_cbranch_vccnz L_retry_13
    s_branch L_go_12
L_spin_14:
    s_mov_b32 s65, 0
L_retry_16:
    s_and_b32 s76, s65, 3
    s_cmp_eq_u32 s76, 0
    s_cbranch_scc0 L_own_17
    s_lshl_b32 s76, s2, 5
    s_mov_b64 exec, 0xff
    buffer_load_dword v24, v36, s[40:43], s76 offen offset:0 sc1
    s_waitcnt vmcnt(0)
    v_cmp_eq_u32 vcc, 0, v24
    s_nop 4
    s_cbranch_vccz L_own_17
    buffer_store_dword v48, v36, s[40:43], s76 offen offset:0 sc1
L_own_17:
    s_mov_b64 exec, -1
    s_sleep 8
    buffer_load_dwordx4 v[24:27], v39, s[40:43], 0 offen offset:0 sc1
    buffer_load_dwordx4 v[28:31], v39, s[40:43], 0 offen offset:1024 sc1
    s_waitcnt vmcnt(0)
    v_min3_u32 v24, v24, v25, v26
    v_min3_u32 v24, v24, v27, v28
    v_min3_u32 v24, v24, v29, v30
    v_min_u32 v24, v24, v31
    v_cmp_eq_u32 vcc, 0, v24
    s_add_u32 s65, s65, 1
    s_cmp_gt_u32 s65, 0x20000
    s_nop 1
    s_cbranch_scc1 L_go_15
    s_cbranch_vccnz L_retry_16
    s_branch L_go_15
L_spin_18:
    s_mov_b32 s65, 0
L_retry_20:
    s_sleep 8
    buffer_load_dword v40, v63, s[40:43], 0 offen sc1
    s_waitcnt vmcnt(0)
    v_or_b32 v40, s44, v40
    v_cmp_eq_u32 vcc, 0, v40
    s_add_u32 s65, s65, 1
    s_cmp_gt_u32 s65, 0x20000
    s_nop 1
    s_cbranch_scc1 L_go_19
    s_cbranch_vccnz L_retry_20
    s_branch L_go_19
L_fast:
    s_add_u32 s60, s3, 0
    s_add_u32 m0, s64, 0
    s_nop 0
    buffer_load_dwordx4 v57, s[40:43], s60 offen offset:0 sc1 lds
    buffer_load_dwordx4 v57, s[40:43], s60 offen offset:1024 sc1 lds
    buffer_load_dwordx4 v57, s[40:43], s60 offen offset:2048 sc1 lds
    buffer_load_dwordx4 v57, s[40:43], s60 offen offset:3072 sc1 lds
    s_add_u32 s60, s3, 262144
    s_add_u32 m0, s64, 4096
    s_nop 0
    buffer_load_dwordx4 v57, s[40:43], s60 offen offset:0 sc1 lds
    buffer_load_dwordx4 v57, s[40:43], s60 offen offset:1024 sc1 lds
    buffer_load_dwordx4 v57, s[40:43], s60 offen offset:2048 sc1 lds
    buffer_load_dwordx4 v57, s[40:43], s60 offen offset:3072 sc1 lds
    s_add_u32 s60, s3, 524288
    s_add_u32 m0, s64, 8192
    s_nop 0
    buffer_load_dwordx4 v57, s[40:43], s60 offen offset:0 sc1 lds
    buffer_load_dwordx4 v57, s[40:43], s60 offen offset:1024 sc1 lds
    s_waitcnt vmcnt(8)
    ds_read_b64_tr_b16 v[128:129], v58 offset:0
    ds_read_b64_tr_b16 v[130:131], v58 offset:1024
    buffer_load_dwordx4 v57, s[40:43], s60 offen offset:2048 sc1 lds
    ds_read_b64_tr_b16 v[132:133], v58 offset:512
    ds_read_b64_tr_b16 v[134:135], v58 offset:1536
    buffer_load_dwordx4 v57, s[40:43], s60 offen offset:3072 sc1 lds
    s_add_u32 s60, s3, 786432
    s_add_u32 m0, s64, 0
    s_waitcnt vmcnt(8)
    ds_read_b64_tr_b16 v[136:137], v58 offset:2048
    ds_read_b64_tr_b16 v[138:139], v58 offset:3072
    s_waitcnt lgkmcnt(2)
    buffer_load_dwordx4 v57, s[40:43], s60 offen offset:0 sc1 lds
    ds_read_b64_tr_b16 v[140:141], v58 offset:2560
    ds_read_b64_tr_b16 v[142:143], v58 offset:3584
    buffer_load_dwordx4 v57, s[40:43], s60 offen offset:1024 sc1 lds
    s_waitcnt vmcnt(8)
    ds_read_b64_tr_b16 v[144:145], v58 offset:4096
    ds_read_b64_tr_b16 v[146:147], v58 offset:5120
    s_waitcnt lgkmcnt(2)
    buffer_load_dwordx4 v57, s[40:43], s60 offen offset:2048 sc1 lds
    ds_read_b64_tr_b16 v[148:149], v58 offset:4608
    ds_read_b64_tr_b16 v[150:151], v58 offset:5632
    buffer_load_dwordx4 v57, s[40:43], s60 offen offset:3072 sc1 lds
    s_add_u32 s60, s3, 1048576
    s_add_u32 m0, s64, 4096
    s_waitcnt vmcnt(8)
    ds_read_b64_tr_b16 v[152:153], v58 offset:6144
    ds_read_b64_tr_b16 v[154:155], v58 offset:7168
    s_waitcnt lgkmcnt(2)
    buffer_load_dwordx4 v57, s[40:43], s60 offen offset:0 sc1 lds
    ds_read_b64_tr_b16 v[156:157], v58 offset:6656
    ds_read_b64_tr_b16 v[158:159], v58 offset:7680
    buffer_load_dwordx4 v57, s[40:43], s60 offen offset:1024 sc1 lds
    s_waitcnt vmcnt(8)
    ds_read_b64_tr_b16 v[160:161], v58 offset:8192
    ds_read_b64_tr_b16 v[162:163], v58 offset:9216
    s_waitcnt lgkmcnt(2)
    buffer_load_dwordx4 v57, s[40:43], s60 offen offset:2048 sc1 lds
    ds_read_b64_tr_b16 v[164:165], v58 offset:8704
    ds_read_b64_tr_b16 v[166:167], v58 offset:9728
    buffer_load_dwordx4 v57, s[40:43], s60 offen offset:3072 sc1 lds
    s_add_u32 s60, s3, 1310720
    s_add_u32 m0, s64, 8192
    s_waitcnt vmcnt(8)
    ds_read_b64_tr_b16 v[168:169], v58 offset:10240
    ds_read_b64_tr_b16 v[170:171], v58 offset:11264
    s_waitcnt lgkmcnt(2)
    buffer_load_dwordx4 v57, s[40:43], s60 offen offset:0 sc1 lds
    ds_read_b64_tr_b16 v[172:173], v58 offset:10752
    ds_read_b64_tr_b16 v[174:175], v58 offset:11776
    buffer_load_dwordx4 v57, s[40:43], s60 offen offset:1024 sc1 lds
    s_waitcnt vmcnt(8)
    ds_read_b64_tr_b16 v[176:177], v58 offset:0
    ds_read_b64_tr_b16 v[178:179], v58 offset:1024
    s_waitcnt lgkmcnt(2)
    buffer_load_dwordx4 v57, s[40:43], s60 offen offset:2048 sc1 lds
    ds_read_b64_tr_b16 v[180:181], v58 offset:512
    ds_read_b64_tr_b16 v[182:183], v58 offset:1536
    buffer_load_dwordx4 v57, s[40:43], s60 offen offset:3072 sc1 lds
    s_add_u32 s60, s3, 1572864
    s_add_u32 m0, s64, 0
    s_waitcnt vmcnt(8)
    ds_read_b64_tr_b16 v[184:185], v58 offset:2048
    ds_read_b64_tr_b16 v[186:187], v58 offset:3072
    s_waitcnt lgkmcnt(2)
    buffer_load_dwordx4 v57, s[40:43], s60 offen offset:0 sc1 lds
    ds_read_b64_tr_b16 v[188:189], v58 offset:2560
    ds_read_b64_tr_b16 v[190:191], v58 offset:3584
    buffer_load_dwordx4 v57, s[40:43], s60 offen offset:1024 sc1 lds
    s_waitcnt vmcnt(8)
    ds_read_b64_tr_b16 v[192:193], v58 offset:4096
    ds_read_b64_tr_b16 v[194:195], v58 offset:5120
    s_waitcnt lgkmcnt(2)
    buffer_load_dwordx4 v57, s[40:43], s60 offen offset:2048 sc1 lds
    ds_read_b64_tr_b16 v[196:197], v58 offset:4608
    ds_read_b64_tr_b16 v[198:199], v58 offset:5632
    buffer_load_dwordx4 v57, s[40:43], s60 offen offset:3072 sc1 lds
    v_lshrrev_b32 v16, 2, v14
    v_min_u32 v16, 13, v16
    v_and_b32 v17, 3, v14
    v_lshlrev_b32 v16, 12, v16
    v_lshl_add_u32 v2, v17, 7, v16
    v_min_u32 v16, 55, v14
    v_lshlrev_b32 v3, 7, v16
    s_mul_i32 s57, s44, 448
    s_mul_i32 s58, s54, 14
    s_add_u32 s57, s57, s58
    s_lshl_b32 s57, s57, 12
    s_xor_b32 s58, s45, 1
    s_lshl_b32 s58, s58, 9
    s_add_u32 s50, s57, s58
    v_mul_u32_u24 v4, 896, v16
    s_waitcnt vmcnt(8)
    ds_read_b64_tr_b16 v[200:201], v58 offset:6144
    ds_read_b64_tr_b16 v[202:203], v58 offset:7168
    ds_read_b64_tr_b16 v[204:205], v58 offset:6656
    ds_read_b64_tr_b16 v[206:207], v58 offset:7680
    s_waitcnt vmcnt(6)
    ds_read_b64_tr_b16 v[208:209], v58 offset:8192
    ds_read_b64_tr_b16 v[210:211], v58 offset:9216
    ds_read_b64_tr_b16 v[212:213], v58 offset:8704
    ds_read_b64_tr_b16 v[214:215], v58 offset:9728
    s_waitcnt vmcnt(4)
    ds_read_b64_tr_b16 v[216:217], v58 offset:10240
    ds_read_b64_tr_b16 v[218:219], v58 offset:11264
    ds_read_b64_tr_b16 v[220:221], v58 offset:10752
    ds_read_b64_tr_b16 v[222:223], v58 offset:11776
    s_waitcnt vmcnt(2)
    ds_read_b64_tr_b16 v[224:225], v58 offset:0
    ds_read_b64_tr_b16 v[226:227], v58 offset:1024
    ds_read_b64_tr_b16 v[228:229], v58 offset:512
    ds_read_b64_tr_b16 v[230:231], v58 offset:1536
    s_waitcnt vmcnt(0)
    ds_read_b64_tr_b16 v[232:233], v58 offset:2048
    ds_read_b64_tr_b16 v[234:235], v58 offset:3072
    ds_read_b64_tr_b16 v[236:237], v58 offset:2560
    ds_read_b64_tr_b16 v[238:239], v58 offset:3584
    s_waitcnt lgkmcnt(0)
    s_barrier
    s_add_u32 s61, s50, 917504
    buffer_load_dword v63, v2, s[24:27], s61 offen
    ds_read_b128 v[16:19], v1 offset:0
    ds_read_b128 v[20:23], v56 offset:0
    ds_read_b128 v[24:27], v1 offset:1024
    ds_read_b128 v[28:31], v56 offset:768
    ds_read_b128 v[32:35], v1 offset:2048
    ds_read_b128 v[36:39], v56 offset:1536
    ds_read_b128 v[40:43], v12 offset:0
    ds_read_b64_tr_b16 v[44:45], v49 offset:0
    ds_read_b64_tr_b16 v[46:47], v49 offset:512
    s_waitcnt lgkmcnt(7)
    v_mfma_f32_16x16x32_bf16 v[64:67], v[16:19], v[128:131], 0
    ds_read_b128 a[224:227], v1 offset:5376
    s_add_u32 s61, s50, 1146880
    v_mfma_f32_16x16x32_bf16 v[88:91], v[16:19], v[132:135], 0
    ds_read_b64_tr_b16 a[252:253], v49 offset:1024
    ds_read_b64_tr_b16 a[254:255], v49 offset:1536
    v_mfma_f32_16x16x32_bf16 v[68:71], v[20:23], v[128:131], 0
    ds_read_b128 a[228:231], v56 offset:5376
    v_mfma_f32_16x16x32_bf16 v[92:95], v[20:23], v[132:135], 0
    s_waitcnt lgkmcnt(9)
    v_mfma_f32_16x16x32_bf16 v[72:75], v[24:27], v[128:131], 0
    ds_read_b128 a[232:235], v1 offset:6400
    v_mfma_f32_16x16x32_bf16 v[96:99], v[24:27], v[132:135], 0
    v_mfma_f32_16x16x32_bf16 v[76:79], v[28:31], v[128:131], 0
    ds_read_b128 a[236:239], v56 offset:6144
    v_mfma_f32_16x16x32_bf16 v[100:103], v[28:31], v[132:135], 0
    s_waitcnt lgkmcnt(9)
    v_mfma_f32_16x16x32_bf16 v[80:83], v[128:131], v[32:35], 0
    ds_read_b128 a[240:243], v1 offset:7424
    v_mfma_f32_16x16x32_bf16 v[104:107], v[132:135], v[32:35], 0
    v_mfma_f32_16x16x32_bf16 v[84:87], v[128:131], v[36:39], 0
    ds_read_b128 a[244:247], v56 offset:6912
    v_mfma_f32_16x16x32_bf16 v[108:111], v[132:135], v[36:39], 0
    s_waitcnt lgkmcnt(8)
    v_mfma_f32_16x16x32_bf16 v[112:115], v[40:43], v[44:47], 0
    ds_read_b128 a[248:251], v12 offset:5376
    v_mfma_f32_16x16x32_bf16 v[116:119], v[44:47], v[40:43], 0
    s_waitcnt lgkmcnt(5)
    v_mfma_f32_16x16x32_bf16 v[64:67], a[224:227], v[136:139], v[64:67]
    ds_read_b128 v[16:19], v1 offset:10752
    v_mfma_f32_16x16x32_bf16 v[88:91], a[224:227], v[140:143], v[88:91]
    ds_read_b64_tr_b16 v[44:45], v49 offset:2048
    ds_read_b64_tr_b16 v[46:47], v49 offset:2560
    v_mfma_f32_16x16x32_bf16 v[68:71], a[228:231], v[136:139], v[68:71]
    ds_read_b128 v[20:23], v56 offset:10752
    v_mfma_f32_16x16x32_bf16 v[92:95], a[228:231], v[140:143], v[92:95]
    s_waitcnt lgkmcnt(7)
    v_mfma_f32_16x16x32_bf16 v[72:75], a[232:235], v[136:139], v[72:75]
    ds_read_b128 v[24:27], v1 offset:11776
    v_mfma_f32_16x16x32_bf16 v[96:99], a[232:235], v[140:143], v[96:99]
    v_mfma_f32_16x16x32_bf16 v[76:79], a[236:239], v[136:139], v[76:79]
    ds_read_b128 v[28:31], v56 offset:11520
    v_mfma_f32_16x16x32_bf16 v[100:103], a[236:239], v[140:143], v[100:103]
    s_waitcnt lgkmcnt(7)
    v_mfma_f32_16x16x32_bf16 v[80:83], v[136:139], a[240:243], v[80:83]
    ds_read_b128 v[32:35], v1 offset:12800
    v_mfma_f32_16x16x32_bf16 v[104:107], v[140:143], a[240:243], v[104:107]
    v_mfma_f32_16x16x32_bf16 v[84:87], v[136:139], a[244:247], v[84:87]
    ds_read_b128 v[36:39], v56 offset:12288
    v_mfma_f32_16x16x32_bf16 v[108:111], v[140:143], a[244:247], v[108:111]
    s_waitcnt lgkmcnt(8)
    v_mfma_f32_16x16x32_bf16 v[112:115], a[248:251], a[252:255], v[112:115]
    ds_read_b128 v[40:43], v12 offset:10752
    v_mfma_f32_16x16x32_bf16 v[116:119], a[252:255], a[248:251], v[116:119]
    s_waitcnt lgkmcnt(5)
    v_mfma_f32_16x16x32_bf16 v[64:67], v[16:19], v[144:147], v[64:67]
    ds_read_b128 a[224:227], v1 offset:16128
    v_mfma_f32_16x16x32_bf16 v[88:91], v[16:19], v[148:151], v[88:91]
    ds_read_b64_tr_b16 a[252:253], v49 offset:3072
    ds_read_b64_tr_b16 a[254:255], v49 offset:3584
    v_mfma_f32_16x16x32_bf16 v[68:71], v[20:23], v[144:147], v[68:71]
    ds_read_b128 a[228:231], v56 offset:16128
    v_mfma_f32_16x16x32_bf16 v[92:95], v[20:23], v[148:151], v[92:95]
    s_waitcnt lgkmcnt(7)
    v_mfma_f32_16x16x32_bf16 v[72:75], v[24:27], v[144:147], v[72:75]
    ds_read_b128 a[232:235], v1 offset:17152
    v_mfma_f32_16x16x32_bf16 v[96:99], v[24:27], v[148:151], v[96:99]
    v_mfma_f32_16x16x32_bf16 v[76:79], v[28:31], v[144:147], v[76:79]
    ds_read_b128 a[236:239], v56 offset:16896
    s_waitcnt vmcnt(0)
    buffer_load_dword v63, v2, s[24:27], s61 offen
    v_mfma_f32_16x16x32_bf16 v[100:103], v[28:31], v[148:151], v[100:103]
    s_waitcnt lgkmcnt(7)
    s_add_u32 s61, s50, 1376256
    v_mfma_f32_16x16x32_bf16 v[80:83], v[144:147], v[32:35], v[80:83]
    ds_read_b128 a[240:243], v1 offset:18176
    v_mfma_f32_16x16x32_bf16 v[104:107], v[148:151], v[32:35], v[104:107]
    v_mfma_f32_16x16x32_bf16 v[84:87], v[144:147], v[36:39], v[84:87]
    ds_read_b128 a[244:247], v56 offset:17664
    v_mfma_f32_16x16x32_bf16 v[108:111], v[148:151], v[36:39], v[108:111]
    s_waitcnt lgkmcnt(8)
    v_mfma_f32_16x16x32_bf16 v[112:115], v[40:43], v[44:47], v[112:115]
    ds_read_b128 a[248:251], v12 offset:16128
    v_mfma_f32_16x16x32_bf16 v[116:119], v[44:47], v[40:43], v[116:119]
    s_waitcnt lgkmcnt(5)
    v_mfma_f32_16x16x32_bf16 v[64:67], a[224:227], v[152:155], v[64:67]
    ds_read_b128 v[16:19], v1 offset:21504
    v_mfma_f32_16x16x32_bf16 v[88:91], a[224:227], v[156:159], v[88:91]
    ds_read_b64_tr_b16 v[44:45], v49 offset:4096
    ds_read_b64_tr_b16 v[46:47], v49 offset:4608
    v_mfma_f32_16x16x32_bf16 v[68:71], a[228:231], v[152:155], v[68:71]
    ds_read_b128 v[20:23], v56 offset:21504
    v_mfma_f32_16x16x32_bf16 v[92:95], a[228:231], v[156:159], v[92:95]
    s_waitcnt lgkmcnt(7)
    v_mfma_f32_16x16x32_bf16 v[72:75], a[232:235], v[152:155], v[72:75]
    ds_read_b128 v[24:27], v1 offset:22528
    v_mfma_f32_16x16x32_bf16 v[96:99], a[232:235], v[156:159], v[96:99]
    v_mfma_f32_16x16x32_bf16 v[76:79], a[236:239], v[152:155], v[76:79]
    ds_read_b128 v[28:31], v56 offset:22272
    v_mfma_f32_16x16x32_bf16 v[100:103], a[236:239], v[156:159], v[100:103]
    s_waitcnt lgkmcnt(7)
    v_mfma_f32_16x16x32_bf16 v[80:83], v[152:155], a[240:243], v[80:83]
    ds_read_b128 v[32:35], v1 offset:23552
    v_mfma_f32_16x16x32_bf16 v[104:107], v[156:159], a[240:243], v[104:107]
    v_mfma_f32_16x16x32_bf16 v[84:87], v[152:155], a[244:247], v[84:87]
    ds_read_b128 v[36:39], v56 offset:23040
    v_mfma_f32_16x16x32_bf16 v[108:111], v[156:159], a[244:247], v[108:111]
    s_waitcnt lgkmcnt(8)
    v_mfma_f32_16x16x32_bf16 v[112:115], a[248:251], a[252:255], v[112:115]
    ds_read_b128 v[40:43], v12 offset:21504
    v_mfma_f32_16x16x32_bf16 v[116:119], a[252:255], a[248:251], v[116:119]
    s_waitcnt lgkmcnt(5)
    v_mfma_f32_16x16x32_bf16 v[64:67], v[16:19], v[160:163], v[64:67]
    ds_read_b128 a[224:227], v1 offset:26880
    v_mfma_f32_16x16x32_bf16 v[88:91], v[16:19], v[164:167], v[88:91]
    ds_read_b64_tr_b16 a[252:253], v49 offset:5120
    ds_read_b64_tr_b16 a[254:255], v49 offset:5632
    v_mfma_f32_16x16x32_bf16 v[68:71], v[20:23], v[160:163], v[68:71]
    ds_read_b128 a[228:231], v56 offset:26880
    v_mfma_f32_16x16x32_bf16 v[92:95], v[20:23], v[164:167], v[92:95]
    s_waitcnt lgkmcnt(7)
    v_mfma_f32_16x16x32_bf16 v[72:75], v[24:27], v[160:163], v[72:75]
    ds_read_b128 a[232:235], v1 offset:27904
    v_mfma_f32_16x16x32_bf16 v[96:99], v[24:27], v[164:167], v[96:99]
    v_mfma_f32_16x16x32_bf16 v[76:79], v[28:31], v[160:163], v[76:79]
    ds_read_b128 a[236:239], v56 offset:27648
    v_mfma_f32_16x16x32_bf16 v[100:103], v[28:31], v[164:167], v[100:103]
    s_waitcnt lgkmcnt(7)
    v_mfma_f32_16x16x32_bf16 v[80:83], v[160:163], v[32:35], v[80:83]
    ds_read_b128 a[240:243], v1 offset:28928
    v_mfma_f32_16x16x32_bf16 v[104:107], v[164:167], v[32:35], v[104:107]
    v_mfma_f32_16x16x32_bf16 v[84:87], v[160:163], v[36:39], v[84:87]
    ds_read_b128 a[244:247], v56 offset:28416
    v_mfma_f32_16x16x32_bf16 v[108:111], v[164:167], v[36:39], v[108:111]
    s_waitcnt lgkmcnt(8)
    v_mfma_f32_16x16x32_bf16 v[112:115], v[40:43], v[44:47], v[112:115]
    ds_read_b128 a[248:251], v12 offset:26880
    v_mfma_f32_16x16x32_bf16 v[116:119], v[44:47], v[40:43], v[116:119]
    s_waitcnt lgkmcnt(5)
    v_mfma_f32_16x16x32_bf16 v[64:67], a[224:227], v[168:171], v[64:67]
    ds_read_b128 v[16:19], v1 offset:32256
    v_mfma_f32_16x16x32_bf16 v[88:91], a[224:227], v[172:175], v[88:91]
    ds_read_b64_tr_b16 v[44:45], v49 offset:6144
    ds_read_b64_tr_b16 v[46:47], v49 offset:6656
    v_mfma_f32_16x16x32_bf16 v[68:71], a[228:231], v[168:171], v[68:71]
    s_waitcnt vmcnt(0)
    buffer_load_dword v63, v2, s[24:27], s61 offen
    ds_read_b128 v[20:23], v56 offset:32256
    v_mfma_f32_16x16x32_bf16 v[92:95], a[228:231], v[172:175], v[92:95]
    s_waitcnt lgkmcnt(7)
    s_add_u32 s61, s50, 1605632
    v_mfma_f32_16x16x32_bf16 v[72:75], a[232:235], v[168:171], v[72:75]
    ds_read_b128 v[24:27], v1 offset:33280
    v_mfma_f32_16x16x32_bf16 v[96:99], a[232:235], v[172:175], v[96:99]
    v_mfma_f32_16x16x32_bf16 v[76:79], a[236:239], v[168:171], v[76:79]
    ds_read_b128 v[28:31], v56 offset:33024
    v_mfma_f32_16x16x32_bf16 v[100:103], a[236:239], v[172:175], v[100:103]
    s_waitcnt lgkmcnt(7)
    v_mfma_f32_16x16x32_bf16 v[80:83], v[168:171], a[240:243], v[80:83]
    ds_read_b128 v[32:35], v1 offset:34304
    v_mfma_f32_16x16x32_bf16 v[104:107], v[172:175], a[240:243], v[104:107]
    v_mfma_f32_16x16x32_bf16 v[84:87], v[168:171], a[244:247], v[84:87]
    ds_read_b128 v[36:39], v56 offset:33792
    v_mfma_f32_16x16x32_bf16 v[108:111], v[172:175], a[244:247], v[108:111]
    s_waitcnt lgkmcnt(8)
    v_mfma_f32_16x16x32_bf16 v[112:115], a[248:251], a[252:255], v[112:115]
    ds_read_b128 v[40:43], v12 offset:32256
    v_mfma_f32_16x16x32_bf16 v[116:119], a[252:255], a[248:251], v[116:119]
    s_waitcnt lgkmcnt(5)
    v_mfma_f32_16x16x32_bf16 v[64:67], v[16:19], v[176:179], v[64:67]
    ds_read_b128 a[224:227], v1 offset:37632
    v_mfma_f32_16x16x32_bf16 v[88:91], v[16:19], v[180:183], v[88:91]
    ds_read_b64_tr_b16 a[252:253], v49 offset:7168
    ds_read_b64_tr_b16 a[254:255], v49 offset:7680
    v_mfma_f32_16x16x32_bf16 v[68:71], v[20:23], v[176:179], v[68:71]
    ds_read_b128 a[228:231], v56 offset:37632
    v_mfma_f32_16x16x32_bf16 v[92:95], v[20:23], v[180:183], v[92:95]
    s_waitcnt lgkmcnt(7)
    v_mfma_f32_16x16x32_bf16 v[72:75], v[24:27], v[176:179], v[72:75]
    ds_read_b128 a[232:235], v1 offset:38656
    v_mfma_f32_16x16x32_bf16 v[96:99], v[24:27], v[180:183], v[96:99]
    v_mfma_f32_16x16x32_bf16 v[76:79], v[28:31], v[176:179], v[76:79]
    ds_read_b128 a[236:239], v56 offset:38400
    v_mfma_f32_16x16x32_bf16 v[100:103], v[28:31], v[180:183], v[100:103]
    s_waitcnt lgkmcnt(7)
    v_mfma_f32_16x16x32_bf16 v[80:83], v[176:179], v[32:35], v[80:83]
    ds_read_b128 a[240:243], v1 offset:39680
    v_mfma_f32_16x16x32_bf16 v[104:107], v[180:183], v[32:35], v[104:107]
    v_mfma_f32_16x16x32_bf16 v[84:87], v[176:179], v[36:39], v[84:87]
    ds_read_b128 a[244:247], v56 offset:39168
    v_mfma_f32_16x16x32_bf16 v[108:111], v[180:183], v[36:39], v[108:111]
    s_waitcnt lgkmcnt(8)
    v_mfma_f32_16x16x32_bf16 v[112:115], v[40:43], v[44:47], v[112:115]
    ds_read_b128 a[248:251], v12 offset:37632
    v_mfma_f32_16x16x32_bf16 v[116:119], v[44:47], v[40:43], v[116:119]
    s_waitcnt lgkmcnt(5)
    v_mfma_f32_16x16x32_bf16 v[64:67], a[224:227], v[184:187], v[64:67]
    ds_read_b128 v[16:19], v1 offset:43008
    v_mfma_f32_16x16x32_bf16 v[88:91], a[224:227], v[188:191], v[88:91]
    ds_read_b64_tr_b16 v[44:45], v49 offset:8192
    ds_read_b64_tr_b16 v[46:47], v49 offset:8704
    v_mfma_f32_16x16x32_bf16 v[68:71], a[228:231], v[184:187], v[68:71]
    ds_read_b128 v[20:23], v56 offset:43008
    v_mfma_f32_16x16x32_bf16 v[92:95], a[228:231], v[188:191], v[92:95]
    s_waitcnt lgkmcnt(7)
    v_mfma_f32_16x16x32_bf16 v[72:75], a[232:235], v[184:187], v[72:75]
    ds_read_b128 v[24:27], v1 offset:44032
    v_mfma_f32_16x16x32_bf16 v[96:99], a[232:235], v[188:191], v[96:99]
    v_mfma_f32_16x16x32_bf16 v[76:79], a[236:239], v[184:187], v[76:79]
    ds_read_b128 v[28:31], v56 offset:43776
    v_mfma_f32_16x16x32_bf16 v[100:103], a[236:239], v[188:191], v[100:103]
    s_waitcnt lgkmcnt(7)
    v_mfma_f32_16x16x32_bf16 v[80:83], v[184:187], a[240:243], v[80:83]
    ds_read_b128 v[32:35], v1 offset:45056
    v_mfma_f32_16x16x32_bf16 v[104:107], v[188:191], a[240:243], v[104:107]
    v_mfma_f32_16x16x32_bf16 v[84:87], v[184:187], a[244:247], v[84:87]
    ds_read_b128 v[36:39], v56 offset:44544
    v_mfma_f32_16x16x32_bf16 v[108:111], v[188:191], a[244:247], v[108:111]
    s_waitcnt lgkmcnt(8)
    s_waitcnt vmcnt(0)
    buffer_load_dword v63, v2, s[24:27], s61 offen
    v_mfma_f32_16x16x32_bf16 v[112:115], a[248:251], a[252:255], v[112:115]
    ds_read_b128 v[40:43], v12 offset:43008
    s_add_u32 s61, s22, 0
    v_mfma_f32_16x16x32_bf16 v[116:119], a[252:255], a[248:251], v[116:119]
    s_waitcnt lgkmcnt(5)
    v_mfma_f32_16x16x32_bf16 v[64:67], v[16:19], v[192:195], v[64:67]
    ds_read_b128 a[224:227], v11 offset:0
    v_mfma_f32_16x16x32_bf16 v[88:91], v[16:19], v[196:199], v[88:91]
    ds_read_b64_tr_b16 a[252:253], v49 offset:9216
    ds_read_b64_tr_b16 a[254:255], v49 offset:9728
    v_mfma_f32_16x16x32_bf16 v[68:71], v[20:23], v[192:195], v[68:71]
    ds_read_b128 a[228:231], v60 offset:0
    v_mfma_f32_16x16x32_bf16 v[92:95], v[20:23], v[196:199], v[92:95]
    s_waitcnt lgkmcnt(7)
    v_mfma_f32_16x16x32_bf16 v[72:75], v[24:27], v[192:195], v[72:75]
    ds_read_b128 a[232:235], v11 offset:1024
    v_mfma_f32_16x16x32_bf16 v[96:99], v[24:27], v[196:199], v[96:99]
    v_mfma_f32_16x16x32_bf16 v[76:79], v[28:31], v[192:195], v[76:79]
    ds_read_b128 a[236:239], v60 offset:768
    v_mfma_f32_16x16x32_bf16 v[100:103], v[28:31], v[196:199], v[100:103]
    s_waitcnt lgkmcnt(7)
    v_mfma_f32_16x16x32_bf16 v[80:83], v[192:195], v[32:35], v[80:83]
    ds_read_b128 a[240:243], v11 offset:2048
    v_mfma_f32_16x16x32_bf16 v[104:107], v[196:199], v[32:35], v[104:107]
    v_mfma_f32_16x16x32_bf16 v[84:87], v[192:195], v[36:39], v[84:87]
    ds_read_b128 a[244:247], v60 offset:1536
    v_mfma_f32_16x16x32_bf16 v[108:111], v[196:199], v[36:39], v[108:111]
    s_waitcnt lgkmcnt(8)
    v_mfma_f32_16x16x32_bf16 v[112:115], v[40:43], v[44:47], v[112:115]
    ds_read_b128 a[248:251], v13 offset:0
    v_mfma_f32_16x16x32_bf16 v[116:119], v[44:47], v[40:43], v[116:119]
    s_waitcnt lgkmcnt(5)
    v_mfma_f32_16x16x32_bf16 v[64:67], a[224:227], v[200:203], v[64:67]
    ds_read_b128 v[16:19], v11 offset:5376
    v_mfma_f32_16x16x32_bf16 v[88:91], a[224:227], v[204:207], v[88:91]
    ds_read_b64_tr_b16 v[44:45], v49 offset:10240
    ds_read_b64_tr_b16 v[46:47], v49 offset:10752
    v_mfma_f32_16x16x32_bf16 v[68:71], a[228:231], v[200:203], v[68:71]
    ds_read_b128 v[20:23], v60 offset:5376
    v_mfma_f32_16x16x32_bf16 v[92:95], a[228:231], v[204:207], v[92:95]
    s_waitcnt lgkmcnt(7)
    v_mfma_f32_16x16x32_bf16 v[72:75], a[232:235], v[200:203], v[72:75]
    ds_read_b128 v[24:27], v11 offset:6400
    v_mfma_f32_16x16x32_bf16 v[96:99], a[232:235], v[204:207], v[96:99]
    v_mfma_f32_16x16x32_bf16 v[76:79], a[236:239], v[200:203], v[76:79]
    ds_read_b128 v[28:31], v60 offset:6144
    v_mfma_f32_16x16x32_bf16 v[100:103], a[236:239], v[204:207], v[100:103]
    s_waitcnt lgkmcnt(7)
    v_mfma_f32_16x16x32_bf16 v[80:83], v[200:203], a[240:243], v[80:83]
    ds_read_b128 v[32:35], v11 offset:7424
    v_mfma_f32_16x16x32_bf16 v[104:107], v[204:207], a[240:243], v[104:107]
    v_mfma_f32_16x16x32_bf16 v[84:87], v[200:203], a[244:247], v[84:87]
    ds_read_b128 v[36:39], v60 offset:6912
    v_mfma_f32_16x16x32_bf16 v[108:111], v[204:207], a[244:247], v[108:111]
    s_waitcnt lgkmcnt(8)
    v_mfma_f32_16x16x32_bf16 v[112:115], a[248:251], a[252:255], v[112:115]
    ds_read_b128 v[40:43], v13 offset:5376
    v_mfma_f32_16x16x32_bf16 v[116:119], a[252:255], a[248:251], v[116:119]
    s_waitcnt lgkmcnt(5)
    v_mfma_f32_16x16x32_bf16 v[64:67], v[16:19], v[208:211], v[64:67]
    ds_read_b128 a[224:227], v11 offset:10752
    v_mfma_f32_16x16x32_bf16 v[88:91], v[16:19], v[212:215], v[88:91]
    ds_read_b64_tr_b16 a[252:253], v49 offset:11264
    ds_read_b64_tr_b16 a[254:255], v49 offset:11776
    v_mfma_f32_16x16x32_bf16 v[68:71], v[20:23], v[208:211], v[68:71]
    ds_read_b128 a[228:231], v60 offset:10752
    v_mfma_f32_16x16x32_bf16 v[92:95], v[20:23], v[212:215], v[92:95]
    s_waitcnt lgkmcnt(7)
    v_mfma_f32_16x16x32_bf16 v[72:75], v[24:27], v[208:211], v[72:75]
    ds_read_b128 a[232:235], v11 offset:11776
    v_mfma_f32_16x16x32_bf16 v[96:99], v[24:27], v[212:215], v[96:99]
    v_mfma_f32_16x16x32_bf16 v[76:79], v[28:31], v[208:211], v[76:79]
    ds_read_b128 a[236:239], v60 offset:11520
    v_mfma_f32_16x16x32_bf16 v[100:103], v[28:31], v[212:215], v[100:103]
    s_waitcnt vmcnt(0)
    buffer_load_dword v63, v4, s[12:15], s61 offen
    s_waitcnt lgkmcnt(7)
    v_mfma_f32_16x16x32_bf16 v[80:83], v[208:211], v[32:35], v[80:83]
    ds_read_b128 a[240:243], v11 offset:12800
    s_add_u32 s61, s22, 50176
    v_mfma_f32_16x16x32_bf16 v[104:107], v[212:215], v[32:35], v[104:107]
    v_mfma_f32_16x16x32_bf16 v[84:87], v[208:211], v[36:39], v[84:87]
    ds_read_b128 a[244:247], v60 offset:12288
    v_mfma_f32_16x16x32_bf16 v[108:111], v[212:215], v[36:39], v[108:111]
    s_waitcnt lgkmcnt(8)
    v_mfma_f32_16x16x32_bf16 v[112:115], v[40:43], v[44:47], v[112:115]
    ds_read_b128 a[248:251], v13 offset:10752
    v_mfma_f32_16x16x32_bf16 v[116:119], v[44:47], v[40:43], v[116:119]
    s_waitcnt lgkmcnt(5)
    v_mfma_f32_16x16x32_bf16 v[64:67], a[224:227], v[216:219], v[64:67]
    ds_read_b128 v[16:19], v11 offset:16128
    v_mfma_f32_16x16x32_bf16 v[88:91], a[224:227], v[220:223], v[88:91]
    ds_read_b64_tr_b16 v[44:45], v49 offset:12288
    ds_read_b64_tr_b16 v[46:47], v49 offset:12800
    v_mfma_f32_16x16x32_bf16 v[68:71], a[228:231], v[216:219], v[68:71]
    ds_read_b128 v[20:23], v60 offset:16128
    v_mfma_f32_16x16x32_bf16 v[92:95], a[228:231], v[220:223], v[92:95]
    s_waitcnt lgkmcnt(7)
    v_mfma_f32_16x16x32_bf16 v[72:75], a[232:235], v[216:219], v[72:75]
    ds_read_b128 v[24:27], v11 offset:17152
    v_mfma_f32_16x16x32_bf16 v[96:99], a[232:235], v[220:223], v[96:99]
    v_mfma_f32_16x16x32_bf16 v[76:79], a[236:239], v[216:219], v[76:79]
    ds_read_b128 v[28:31], v60 offset:16896
    v_mfma_f32_16x16x32_bf16 v[100:103], a[236:239], v[220:223], v[100:103]
    s_waitcnt lgkmcnt(7)
    v_mfma_f32_16x16x32_bf16 v[80:83], v[216:219], a[240:243], v[80:83]
    ds_read_b128 v[32:35], v11 offset:18176
    v_mfma_f32_16x16x32_bf16 v[104:107], v[220:223], a[240:243], v[104:107]
    v_mfma_f32_16x16x32_bf16 v[84:87], v[216:219], a[244:247], v[84:87]
    ds_read_b128 v[36:39], v60 offset:17664
    v_mfma_f32_16x16x32_bf16 v[108:111], v[220:223], a[244:247], v[108:111]
    s_waitcnt lgkmcnt(8)
    v_mfma_f32_16x16x32_bf16 v[112:115], a[248:251], a[252:255], v[112:115]
    ds_read_b128 v[40:43], v13 offset:16128
    v_mfma_f32_16x16x32_bf16 v[116:119], a[252:255], a[248:251], v[116:119]
    s_waitcnt lgkmcnt(5)
    v_mfma_f32_16x16x32_bf16 v[64:67], v[16:19], v[224:227], v[64:67]
    ds_read_b128 a[224:227], v11 offset:21504
    v_mfma_f32_16x16x32_bf16 v[88:91], v[16:19], v[228:231], v[88:91]
    ds_read_b64_tr_b16 a[252:253], v49 offset:13312
    ds_read_b64_tr_b16 a[254:255], v49 offset:13824
    v_mfma_f32_16x16x32_bf16 v[68:71], v[20:23], v[224:227], v[68:71]
    ds_read_b128 a[228:231], v60 offset:21504
    v_mfma_f32_16x16x32_bf16 v[92:95], v[20:23], v[228:231], v[92:95]
    s_waitcnt lgkmcnt(7)
    v_mfma_f32_16x16x32_bf16 v[72:75], v[24:27], v[224:227], v[72:75]
    ds_read_b128 a[232:235], v11 offset:22528
    v_mfma_f32_16x16x32_bf16 v[96:99], v[24:27], v[228:231], v[96:99]
    v_mfma_f32_16x16x32_bf16 v[76:79], v[28:31], v[224:227], v[76:79]
    ds_read_b128 a[236:239], v60 offset:22272
    v_mfma_f32_16x16x32_bf16 v[100:103], v[28:31], v[228:231], v[100:103]
    s_waitcnt lgkmcnt(7)
    v_mfma_f32_16x16x32_bf16 v[80:83], v[224:227], v[32:35], v[80:83]
    ds_read_b128 a[240:243], v11 offset:23552
    v_mfma_f32_16x16x32_bf16 v[104:107], v[228:231], v[32:35], v[104:107]
    v_mfma_f32_16x16x32_bf16 v[84:87], v[224:227], v[36:39], v[84:87]
    ds_read_b128 a[244:247], v60 offset:23040
    v_mfma_f32_16x16x32_bf16 v[108:111], v[228:231], v[36:39], v[108:111]
    s_waitcnt lgkmcnt(8)
    v_mfma_f32_16x16x32_bf16 v[112:115], v[40:43], v[44:47], v[112:115]
    ds_read_b128 a[248:251], v13 offset:21504
    v_mfma_f32_16x16x32_bf16 v[116:119], v[44:47], v[40:43], v[116:119]
    s_waitcnt lgkmcnt(5)
    v_mfma_f32_16x16x32_bf16 v[64:67], a[224:227], v[232:235], v[64:67]
    v_mfma_f32_16x16x32_bf16 v[88:91], a[224:227], v[236:239], v[88:91]
    v_mfma_f32_16x16x32_bf16 v[68:71], a[228:231], v[232:235], v[68:71]
    v_mfma_f32_16x16x32_bf16 v[92:95], a[228:231], v[236:239], v[92:95]
    s_waitcnt vmcnt(0)
    buffer_load_dword v63, v4, s[12:15], s61 offen
    s_waitcnt lgkmcnt(3)
    v_mfma_f32_16x16x32_bf16 v[72:75], a[232:235], v[232:235], v[72:75]
    v_mfma_f32_16x16x32_bf16 v[96:99], a[232:235], v[236:239], v[96:99]
    v_mfma_f32_16x16x32_bf16 v[76:79], a[236:239], v[232:235], v[76:79]
    v_mfma_f32_16x16x32_bf16 v[100:103], a[236:239], v[236:239], v[100:103]
    s_waitcnt lgkmcnt(1)
    v_mfma_f32_16x16x32_bf16 v[80:83], v[232:235], a[240:243], v[80:83]
    v_mfma_f32_16x16x32_bf16 v[104:107], v[236:239], a[240:243], v[104:107]
    v_mfma_f32_16x16x32_bf16 v[84:87], v[232:235], a[244:247], v[84:87]
    v_mfma_f32_16x16x32_bf16 v[108:111], v[236:239], a[244:247], v[108:111]
    s_waitcnt lgkmcnt(0)
    v_mfma_f32_16x16x32_bf16 v[112:115], a[248:251], a[252:255], v[112:115]
    v_mfma_f32_16x16x32_bf16 v[116:119], a[252:255], a[248:251], v[116:119]
    v_cvt_pk_bf16_f32 v32, v96, v97
    v_cvt_pk_bf16_f32 v33, v98, v99
    v_cvt_pk_bf16_f32 v34, v100, v101
    v_cvt_pk_bf16_f32 v35, v102, v103
    ds_write_b128 v50, v[32:35] offset:2048
    v_cvt_pk_bf16_f32 v40, v104, v105
    v_cvt_pk_bf16_f32 v46, v108, v109
    v_cvt_pk_bf16_f32 v41, v106, v107
    v_cvt_pk_bf16_f32 v47, v110, v111
    ds_write_b64 v50, v[40:41] offset:3072
    ds_write_b64 v50, v[46:47] offset:3080
    v_cvt_pk_bf16_f32 v96, v112, v113
    v_cvt_pk_bf16_f32 v97, v114, v115
    v_cvt_pk_bf16_f32 v98, v116, v117
    v_cvt_pk_bf16_f32 v99, v118, v119
    v_cndmask_b32 v96, v98, v96, s[78:79]
    v_cndmask_b32 v97, v99, v97, s[78:79]
    ds_write_b64 v51, v[96:97]
    v_cvt_pk_bf16_f32 v28, v72, v73
    v_cvt_pk_bf16_f32 v29, v74, v75
    v_cvt_pk_bf16_f32 v30, v76, v77
    v_cvt_pk_bf16_f32 v31, v78, v79
    v_cvt_pk_bf16_f32 v16, v64, v65
    v_cvt_pk_bf16_f32 v17, v66, v67
    v_cvt_pk_bf16_f32 v18, v68, v69
    v_cvt_pk_bf16_f32 v19, v70, v71
    v_and_b32 v18, v54, v18
    v_and_b32 v19, v54, v19
    v_cvt_pk_bf16_f32 v20, v88, v89
    v_cvt_pk_bf16_f32 v21, v90, v91
    v_cvt_pk_bf16_f32 v22, v92, v93
    v_cvt_pk_bf16_f32 v23, v94, v95
    v_and_b32 v22, v54, v22
    v_and_b32 v23, v54, v23
    s_waitcnt lgkmcnt(0)
    s_barrier
    ds_read_b128 v[24:27], v50
    ds_read_b64 v[36:37], v50 offset:1024
    ds_read_b64 v[42:43], v50 offset:1032
    v_mfma_f32_16x16x32_bf16 v[72:75], v[28:31], v[20:23], 0
    v_mfma_f32_16x16x32_bf16 v[76:79], v[32:35], v[20:23], 0
    v_mfma_f32_16x16x32_bf16 v[68:71], v[28:31], v[16:19], 0
    v_cvt_pk_bf16_f32 v38, v80, v81
    v_cvt_pk_bf16_f32 v44, v84, v85
    v_cvt_pk_bf16_f32 v39, v82, v83
    v_cvt_pk_bf16_f32 v45, v86, v87
    s_waitcnt lgkmcnt(2)
    v_mfma_f32_16x16x32_bf16 v[64:67], v[24:27], v[16:19], v[244:247]
    s_nop 0
    v_cndmask_b32 v76, v76, v77, s[70:71]
    v_cndmask_b32 v78, v78, v79, s[70:71]
    v_cndmask_b32 v72, v72, v73, s[70:71]
    v_cndmask_b32 v74, v74, v75, s[70:71]
    v_cndmask_b32 v90, v72, v76, s[72:73]
    v_cndmask_b32 v91, v74, v78, s[74:75]
    v_pk_mul_f32 v[90:91], v[90:91], v[250:251]
    v_max_f32 v93, v90, v91
    v_cndmask_b32 v68, v68, v69, s[70:71]
    v_cndmask_b32 v70, v70, v71, s[70:71]
    v_cndmask_b32 v64, v64, v65, s[70:71]
    v_cndmask_b32 v66, v66, v67, s[70:71]
    v_cndmask_b32 v88, v64, v68, s[72:73]
    v_cndmask_b32 v89, v66, v70, s[74:75]
    v_pk_mul_f32 v[88:89], v[88:89], v[248:249]
    v_max_f32 v92, v88, v89
    s_nop 1
    v_permlane32_swap_b32 v92, v93
    v_max_f32 v92, v92, v93
    v_mov_b32 v93, v92
    s_nop 1
    v_permlane16_swap_b32 v92, v93
    v_max_f32 v92, v92, v93
    v_mov_b32 v93, v92
    s_nop 1
    v_permlane32_swap_b32 v92, v93
    v_sub_f32 v88, v88, v92
    v_sub_f32 v89, v89, v92
    v_sub_f32 v90, v90, v93
    v_sub_f32 v91, v91, v93
    v_exp_f32 v88, v88
    v_exp_f32 v89, v89
    v_exp_f32 v90, v90
    v_exp_f32 v91, v91
    v_add_f32 v92, v88, v89
    v_add_f32 v93, v90, v91
    v_pk_mul_f32 v[88:89], v[88:89], v[252:253]
    v_pk_mul_f32 v[90:91], v[90:91], v[254:255]
    v_permlane32_swap_b32 v92, v93
    v_add_f32 v92, v92, v93
    v_mov_b32 v93, v92
    s_nop 1
    v_permlane16_swap_b32 v92, v93
    v_add_f32 v92, v92, v93
    v_rcp_f32 v92, v92
    s_nop 0
    v_mov_b32 v93, v92
    s_nop 1
    v_permlane32_swap_b32 v92, v93
    v_mul_f32 v88, v88, v92
    v_mul_f32 v89, v89, v92
    v_mul_f32 v90, v90, v93
    v_mul_f32 v91, v91, v93
    v_cvt_pk_bf16_f32 v88, v88, v88
    v_cvt_pk_bf16_f32 v89, v89, v89
    v_cvt_pk_bf16_f32 v90, v90, v90
    v_cvt_pk_bf16_f32 v91, v91, v91
    v_and_b32 v96, v88, v240
    v_and_b32 v97, v89, v241
    v_and_b32 v98, v88, v242
    v_and_b32 v99, v89, v243
    v_and_b32 v100, v90, v240
    v_and_b32 v101, v91, v241
    v_and_b32 v102, v90, v242
    v_and_b32 v103, v91, v243
    s_waitcnt lgkmcnt(0)
    v_mfma_f32_16x16x32_bf16 v[104:107], v[36:39], v[96:99], 0
    v_mfma_f32_16x16x32_bf16 v[108:111], v[42:45], v[96:99], 0
    v_mfma_f32_16x16x32_bf16 v[112:115], v[38:41], v[100:103], 0
    v_mfma_f32_16x16x32_bf16 v[116:119], v[44:47], v[100:103], 0
    s_nop 4
    v_cvt_pk_bf16_f32 v16, v104, v105
    v_cvt_pk_bf16_f32 v17, v106, v107
    v_cvt_pk_bf16_f32 v18, v108, v109
    v_cvt_pk_bf16_f32 v19, v110, v111
    v_cvt_pk_bf16_f32 v20, v112, v113
    v_cvt_pk_bf16_f32 v21, v114, v115
    v_cvt_pk_bf16_f32 v22, v116, v117
    v_cvt_pk_bf16_f32 v23, v118, v119
    v_and_b32 v18, v54, v18
    v_and_b32 v19, v54, v19
    v_and_b32 v22, v54, v22
    v_and_b32 v23, v54, v23
    buffer_store_dwordx4 v[16:19], v1, s[40:43], s23 offen sc1
    buffer_store_dwordx4 v[20:23], v1, s[40:43], s63 offen sc1
    s_waitcnt vmcnt(0)
    s_mov_b64 exec, 1
    buffer_store_dword v61, v15, s[40:43], s66 offen offset:128 sc1
    s_mov_b64 exec, -1
    s_endpgm
L_idle:
    v_mov_b32 v61, 1
    s_mov_b32 s38, 0x100
    s_mov_b32 s39, 0x20000
    s_mov_b32 s10, 0x126000
    s_mov_b32 s11, 0x20000
    s_mov_b32 s14, 0x62000
    s_mov_b32 s15, 0x20000
    s_mov_b32 s22, 0xe00
    s_mov_b32 s23, 0x20000
    s_mov_b32 s26, 0x700000
    s_mov_b32 s27, 0x20000
    s_mov_b32 s30, 0x1000
    s_mov_b32 s31, 0x20000
    s_mov_b32 s34, 0x1c0000
    s_mov_b32 s35, 0x20000
    s_lshr_b32 s51, s46, 1
    s_and_b32 s59, s46, 1
    s_lshl_b32 s52, s45, 1
    s_add_u32 s52, s52, s59
    s_sub_u32 s58, s46, 0
    s_and_b32 s58, s58, 31
    s_mul_i32 s53, s58, 37
    s_lshr_b32 s53, s53, 8
    s_mul_i32 s59, s53, 7
    s_sub_u32 s54, s58, s59
    s_xor_b32 s55, s45, 1
    s_lshl_b32 s55, s55, 2
    s_xor_b32 s59, s53, 0
    s_add_u32 s55, s55, s59
    s_lshl_b32 s66, s2, 8
    s_lshl_b32 s59, s44, 2
    s_add_u32 s66, s66, s59
    s_add_u32 s66, s66, 65536
    s_lshl_b32 s57, s55, 2
    s_add_u32 s57, s57, s44
    s_lshl_b32 s57, s57, 5
    v_and_b32 v16, 15, v14
    v_lshlrev_b32 v16, 1, v16
    s_waitcnt lgkmcnt(0)
    buffer_load_ushort v126, v16, s[28:31], s57 offen
    s_sub_u32 s48, s46, s47
    s_and_b32 s58, s45, 1
    s_lshl_b32 s59, s58, 2
    s_add_u32 s59, s59, 32
    v_cmp_gt_u32 vcc, s59, v14
    s_mul_i32 s57, s59, s48
    s_xor_b32 s58, s58, 1
    s_mul_i32 s58, s58, 288
    s_add_u32 s57, s57, s58
    s_lshl_b32 s58, s44, 9
    s_add_u32 s57, s57, s58
    s_mul_i32 s57, s57, 3584
    s_lshr_b32 s58, s45, 1
    s_mul_i32 s58, s58, 896
    s_add_u32 s57, s57, s58
    v_mul_u32_u24 v16, 3584, v14
    v_bfrev_b32 v17, 2
    v_cndmask_b32 v16, v17, v16, vcc
    buffer_load_dword v254, v16, s[16:19], s57 offen offset:384
    s_lshl_b32 s49, s48, 3
    s_add_u32 s49, s49, s45
    s_lshr_b32 s57, s49, 2
    s_and_b32 s58, s49, 3
    s_mul_i32 s99, s57, 5376
    s_mul_i32 s59, s44, 301056
    s_add_u32 s99, s99, s59
    s_add_u32 s99, s99, 5242880
    s_lshl_b32 s57, s57, 3
    s_add_u32 s57, s57, s58
    s_mul_i32 s57, s57, 10752
    s_lshr_b32 s58, s44, 1
    s_mul_i32 s58, s58, 32256
    s_add_u32 s57, s57, s58
    s_mul_i32 s64, s44, 5376
    s_add_u32 s60, s57, s64
    s_mul_i32 s57, s44, 56
    s_add_u32 s57, s57, s49
    s_lshl_b32 s57, s57, 5
    s_add_u32 s100, s57, 8192
    s_cmp_lt_u32 s48, 7
    s_cselect_b32 s99, s99, 268435456
    s_cselect_b32 s100, s100, 268435456
    s_mul_i32 s57, s44, 1824
    s_add_u32 s57, s57, 102400
    v_add_u32 v32, s57, v1
    v_bfe_u32 v17, v14, 2, 2
    v_and_b32 v19, 3, v14
    v_lshrrev_b32 v20, 4, v14
    v_mul_u32_u24 v33, 912, v17
    v_lshl_add_u32 v33, v19, 3, v33
    v_lshl_add_u32 v33, v20, 5, v33
    s_lshl_b32 s57, s44, 7
    s_add_u32 s57, s57, 102400
    v_add_u32 v33, s57, v33
    v_and_b32 v19, 15, v14
    v_lshlrev_b32 v19, 4, v19
    v_lshl_add_u32 v34, v20, 10, v19
    v_lshrrev_b32 v19, 5, v14
    s_lshl_b32 s57, s44, 3
    s_add_u32 s57, s57, 110592
    v_lshl_add_u32 v35, v19, 2, s57
    v_lshlrev_b32 v36, 2, v14
    v_add_u32 v37, 110592, v36
    s_lshr_b32 s57, s2, 2
    s_lshl_b32 s57, s57, 12
    s_and_b32 s58, s2, 3
    s_lshl_b32 s58, s58, 8
    s_add_u32 s57, s57, s58
    s_lshl_b32 s58, s44, 18
    s_add_u32 s57, s57, s58
    s_add_u32 s62, s57, 3145728
    s_add_u32 s63, s62, 1048576
    s_lshl_b32 s57, s2, 8
    s_add_u32 s57, s57, 65536
    s_cmp_eq_u32 s44, 3
    s_cselect_b32 s63, s57, s63
    s_cselect_b64 s[72:73], 0xffff, -1
    s_cselect_b32 s74, 0, -1
    s_lshl_b32 s69, s2, 5
    s_cmp_eq_u32 s44, 0
    s_cselect_b32 s69, s69, 268435456
    v_mov_b32 v38, 0x3f803f80
    s_waitcnt vmcnt(2)
    v_dot2_f32_bf16 v20, v24, v38, 0
    v_dot2_f32_bf16 v21, v28, v38, 0
    v_dot2_f32_bf16 v20, v25, v38, v20
    v_dot2_f32_bf16 v21, v29, v38, v21
    v_dot2_f32_bf16 v20, v26, v38, v20
    v_dot2_f32_bf16 v21, v30, v38, v21
    v_dot2_f32_bf16 v20, v27, v38, v20
    v_dot2_f32_bf16 v21, v31, v38, v21
    v_lshlrev_b32 v40, 16, v24
    v_and_b32 v41, 0xffff0000, v24
    v_lshlrev_b32 v42, 16, v25
    v_and_b32 v43, 0xffff0000, v25
    v_permlane32_swap_b32 v20, v21
    v_add_f32 v20, v20, v21
    v_mov_b32 v22, v20
    v_lshlrev_b32 v44, 16, v26
    v_and_b32 v45, 0xffff0000, v26
    v_permlane16_swap_b32 v20, v22
    v_add_f32 v20, v20, v22
    v_lshlrev_b32 v46, 16, v27
    v_and_b32 v47, 0xffff0000, v27
    v_add_f32_dpp v20, v20, v20 row_ror:8 row_mask:0xf bank_mask:0xf
    v_lshlrev_b32 v48, 16, v28
    v_and_b32 v49, 0xffff0000, v28
    v_add_f32_dpp v20, v20, v20 row_ror:4 row_mask:0xf bank_mask:0xf
    v_lshlrev_b32 v50, 16, v29
    v_and_b32 v51, 0xffff0000, v29
    v_add_f32_dpp v20, v20, v20 row_ror:2 row_mask:0xf bank_mask:0xf
    v_lshlrev_b32 v52, 16, v30
    v_and_b32 v53, 0xffff0000, v30
    v_add_f32_dpp v20, v20, v20 row_ror:1 row_mask:0xf bank_mask:0xf
    v_lshlrev_b32 v54, 16, v31
    v_and_b32 v55, 0xffff0000, v31
    v_mul_f32 v20, 0xbb124925, v20
    s_nop 0
    v_readlane_b32 s76, v20, 0
    v_readlane_b32 s78, v20, 32
    s_mov_b32 exec_hi, 0x00ffffff
    v_pk_add_f32 v[40:41], v[40:41], s[76:77] op_sel_hi:[1,0]
    v_pk_add_f32 v[42:43], v[42:43], s[76:77] op_sel_hi:[1,0]
    v_pk_add_f32 v[44:45], v[44:45], s[76:77] op_sel_hi:[1,0]
    v_pk_add_f32 v[46:47], v[46:47], s[76:77] op_sel_hi:[1,0]
    v_pk_add_f32 v[48:49], v[48:49], s[78:79] op_sel_hi:[1,0]
    v_pk_add_f32 v[50:51], v[50:51], s[78:79] op_sel_hi:[1,0]
    v_pk_add_f32 v[52:53], v[52:53], s[78:79] op_sel_hi:[1,0]
    v_pk_add_f32 v[54:55], v[54:55], s[78:79] op_sel_hi:[1,0]
    s_mov_b32 exec_hi, -1
    v_pk_mul_f32 v[20:21], v[40:41], v[40:41]
    v_pk_mul_f32 v[22:23], v[48:49], v[48:49]
    v_pk_fma_f32 v[20:21], v[42:43], v[42:43], v[20:21]
    v_pk_fma_f32 v[22:23], v[50:51], v[50:51], v[22:23]
    v_pk_fma_f32 v[20:21], v[44:45], v[44:45], v[20:21]
    v_pk_fma_f32 v[22:23], v[52:53], v[52:53], v[22:23]
    v_pk_fma_f32 v[20:21], v[46:47], v[46:47], v[20:21]
    v_pk_fma_f32 v[22:23], v[54:55], v[54:55], v[22:23]
    v_add_f32 v20, v20, v21
    v_add_f32 v21, v22, v23
    v_mov_b32 v23, 0x3727c5ac
    s_nop 0
    v_permlane32_swap_b32 v20, v21
    v_add_f32 v20, v20, v21
    v_mov_b32 v22, v20
    s_nop 1
    v_permlane16_swap_b32 v20, v22
    v_add_f32 v20, v20, v22
    s_nop 1
    v_add_f32_dpp v20, v20, v20 row_ror:8 row_mask:0xf bank_mask:0xf
    s_nop 1
    v_add_f32_dpp v20, v20, v20 row_ror:4 row_mask:0xf bank_mask:0xf
    s_nop 1
    v_add_f32_dpp v20, v20, v20 row_ror:2 row_mask:0xf bank_mask:0xf
    s_nop 1
    v_add_f32_dpp v20, v20, v20 row_ror:1 row_mask:0xf bank_mask:0xf
    v_mul_f32 v20, 0x3b124925, v20
    v_add_f32 v21, v20, v23
    v_rsq_f32 v21, v21
    s_nop 0
    v_mul_f32 v20, v20, v21
    v_fma_f32 v20, v20, v21, v23
    v_rsq_f32 v22, v20
    s_nop 0
    v_mul_f32 v21, v21, v22
    v_mul_f32 v20, v20, v22
    v_readlane_b32 s76, v21, 0
    v_readlane_b32 s78, v21, 32
    ds_write_b32 v35, v20
    v_pk_mul_f32 v[40:41], v[40:41], s[76:77] op_sel_hi:[1,0]
    v_pk_mul_f32 v[42:43], v[42:43], s[76:77] op_sel_hi:[1,0]
    v_pk_mul_f32 v[44:45], v[44:45], s[76:77] op_sel_hi:[1,0]
    v_pk_mul_f32 v[46:47], v[46:47], s[76:77] op_sel_hi:[1,0]
    v_cvt_pk_bf16_f32 v24, v40, v41
    v_cvt_pk_bf16_f32 v25, v42, v43
    v_cvt_pk_bf16_f32 v26, v44, v45
    v_cvt_pk_bf16_f32 v27, v46, v47
    s_mov_b32 exec_hi, 0x00ffffff
    ds_write_b128 v32, v[24:27]
    v_pk_mul_f32 v[48:49], v[48:49], s[78:79] op_sel_hi:[1,0]
    v_pk_mul_f32 v[50:51], v[50:51], s[78:79] op_sel_hi:[1,0]
    v_pk_mul_f32 v[52:53], v[52:53], s[78:79] op_sel_hi:[1,0]
    v_pk_mul_f32 v[54:55], v[54:55], s[78:79] op_sel_hi:[1,0]
    v_cvt_pk_bf16_f32 v28, v48, v49
    v_cvt_pk_bf16_f32 v29, v50, v51
    v_cvt_pk_bf16_f32 v30, v52, v53
    v_cvt_pk_bf16_f32 v31, v54, v55
    ds_write_b128 v32, v[28:31] offset:912
    s_mov_b32 exec_hi, -1
    s_waitcnt lgkmcnt(0)
    s_barrier
    ds_read_b64_tr_b16 v[40:41], v33
    ds_read_b64_tr_b16 v[42:43], v33 offset:3648
    ds_read_b64_tr_b16 v[44:45], v33 offset:512
    ds_read_b64_tr_b16 v[46:47], v33 offset:4160
    ds_read_b32 v48, v37
    s_waitcnt lgkmcnt(3)
    buffer_store_dwordx4 v[40:43], v34, s[40:43], s62 offen sc1
    s_waitcnt lgkmcnt(1)
    v_and_b32 v44, s74, v44
    v_and_b32 v45, s74, v45
    v_and_b32 v46, s74, v46
    v_and_b32 v47, s74, v47
    s_mov_b64 exec, s[72:73]
    buffer_store_dwordx4 v[44:47], v34, s[40:43], s63 offen sc1
    s_mov_b64 exec, -1
    s_waitcnt lgkmcnt(0)
    s_lshl_b32 s59, s48, 2
    s_add_u32 s59, s59, s44
    s_lshl_b32 s57, s59, 12
    s_xor_b32 s58, s45, 1
    s_lshl_b32 s58, s58, 9
    s_add_u32 s57, s57, s58
    s_cmp_lt_u32 s59, 28
    s_cselect_b32 s50, s57, 268435456
    v_lshrrev_b32 v16, 3, v14
    v_bfe_u32 v17, v14, 2, 1
    v_lshl_add_u32 v16, v16, 4, v17
    v_mul_u32_u24 v16, 114688, v16
    v_and_b32 v17, 3, v14
    v_lshl_add_u32 v32, v17, 7, v16
    v_lshlrev_b32 v33, 7, v14
    s_mul_i32 s98, s59, 14336
    v_bfe_u32 v16, v14, 2, 2
    v_mul_u32_u24 v16, 2688, v16
    v_lshl_add_u32 v16, v17, 3, v16
    v_lshrrev_b32 v18, 4, v14
    v_mul_u32_u24 v19, 56, v18
    s_mul_i32 s57, s44, 224
    v_add3_u32 v34, v16, v19, s57
    v_mul_u32_u24 v18, 75264, v18
    v_and_b32 v19, 15, v14
    v_lshl_add_u32 v18, v19, 4, v18
    s_and_b32 s57, s49, 3
    s_lshl_b32 s58, s57, 8
    v_add_u32 v35, s58, v18
    v_add_u32 v16, 12, v19
    v_lshrrev_b32 v16, 4, v16
    v_xor_b32 v16, s57, v16
    v_and_b32 v16, 1, v16
    v_mul_u32_u24 v16, 192, v16
    s_lshr_b32 s57, s57, 1
    s_mul_i32 s57, s57, 384
    s_add_u32 s57, s57, 3072
    v_add3_u32 v16, v16, v18, s57
    v_bfrev_b32 v17, 2
    v_cmp_gt_u32 vcc, 12, v19
    s_nop 1
    v_cndmask_b32 v37, v17, v16, vcc
    s_waitcnt vmcnt(0)
    s_barrier
    s_mov_b64 exec, 0xff
    buffer_store_dword v48, v36, s[40:43], s69 offen offset:0 sc1
    s_mov_b64 exec, -1
    s_lshl_b32 s57, s44, 11
    v_add_u32 v39, s57, v1
    s_lshr_b32 s57, s52, 2
    s_mul_i32 s57, s57, 1792
    s_add_u32 s57, s57, 8192
    s_lshl_b32 s58, s44, 28
    s_add_u32 s57, s57, s58
    v_min_u32 v63, 55, v14
    v_lshl_add_u32 v63, v63, 5, s57
    s_mov_b32 m0, s64
    s_nop 0
    buffer_load_dwordx4 v1, s[8:11], s60 offen offset:0 lds
    buffer_load_dwordx4 v1, s[8:11], s60 offen offset:1024 lds
    buffer_load_dwordx4 v1, s[8:11], s60 offen offset:2048 lds
    buffer_load_dwordx4 v1, s[8:11], s60 offen offset:3072 lds
    s_add_u32 m0, m0, 4096
    s_add_u32 s60, s60, 4096
    buffer_load_dwordx4 v1, s[8:11], s60 offen offset:0 lds
    s_mov_b64 exec, 0xffff
    buffer_load_dwordx4 v1, s[8:11], s60 offen offset:1024 lds
    s_mov_b64 exec, -1
    s_mul_i32 s57, s45, 1792
    s_add_u32 s57, s57, s98
    s_mov_b64 exec, 0x3fff
    buffer_load_dword v38, v33, s[12:15], s57 offen
    s_mov_b64 exec, -1
    s_mov_b32 exec_hi, 0
    s_add_u32 s61, s50, 0
    buffer_load_dword v125, v32, s[24:27], s61 offen
    s_mov_b64 exec, -1
    s_waitcnt vmcnt(2)
    s_barrier
    ds_read_b64_tr_b16 v[64:65], v34 offset:0
    ds_read_b64_tr_b16 v[66:67], v34 offset:10752
    ds_read_b64_tr_b16 v[68:69], v34 offset:32
    ds_read_b64_tr_b16 v[70:71], v34 offset:10784
    ds_read_b64_tr_b16 v[72:73], v34 offset:896
    ds_read_b64_tr_b16 v[74:75], v34 offset:11648
    ds_read_b64_tr_b16 v[76:77], v34 offset:928
    ds_read_b64_tr_b16 v[78:79], v34 offset:11680
    ds_read_b64_tr_b16 v[80:81], v34 offset:1792
    ds_read_b64_tr_b16 v[82:83], v34 offset:12544
    ds_read_b64_tr_b16 v[84:85], v34 offset:1824
    ds_read_b64_tr_b16 v[86:87], v34 offset:12576
    s_waitcnt lgkmcnt(10)
    buffer_store_dwordx4 v[64:67], v35, s[40:43], s99 offen offset:0 sc1
    s_waitcnt lgkmcnt(8)
    buffer_store_dwordx4 v[68:71], v37, s[40:43], s99 offen offset:0 sc1
    s_waitcnt lgkmcnt(6)
    buffer_store_dwordx4 v[72:75], v35, s[40:43], s99 offen offset:1024 sc1
    s_waitcnt lgkmcnt(4)
    buffer_store_dwordx4 v[76:79], v37, s[40:43], s99 offen offset:768 sc1
    s_waitcnt lgkmcnt(2)
    buffer_store_dwordx4 v[80:83], v35, s[40:43], s99 offen offset:2048 sc1
    s_waitcnt lgkmcnt(0)
    buffer_store_dwordx4 v[84:87], v37, s[40:43], s99 offen offset:1536 sc1
    buffer_load_dwordx4 v[20:23], v15, s[36:39], 0 offen sc1
    s_mov_b32 exec_hi, 0
    s_add_u32 s61, s50, 229376
    buffer_load_dword v125, v32, s[24:27], s61 offen
    s_mov_b64 exec, -1
    s_mov_b32 exec_hi, 0
    s_add_u32 s61, s50, 458752
    buffer_load_dword v125, v32, s[24:27], s61 offen
    s_mov_b64 exec, -1
    s_mul_i32 s59, s52, 75264
    s_add_u32 s59, s59, 5242880
    s_mul_i32 s8, s44, 18432
    s_add_u32 s67, s59, s8
    s_lshl_b32 s57, s44, 10
    s_add_u32 s9, s57, 75776
    s_add_u32 s57, s57, 71680
    s_add_u32 s20, s59, s57
    s_add_u32 s10, s9, 12288
    s_cmp_lt_u32 s44, 2
    s_cselect_b32 s10, s10, s57
    s_lshr_b32 s58, s44, 1
    s_lshl_b32 s57, s51, 2
    s_add_u32 s59, s57, s44
    s_lshl_b32 s59, s59, 12
    s_add_u32 s3, s59, 3145728
    s_max_u32 s57, s57, 1
    s_sub_u32 s57, s57, 1
    s_lshl_b32 s57, s57, 12
    s_add_u32 s57, s57, 3146240
    s_lshl_b32 s59, s44, 11
    s_add_u32 s11, s57, s59
    s_add_u32 s11, s11, 1572864
    s_cmp_lt_u32 s44, 2
    s_cselect_b32 s11, s11, s20
    s_lshl_b32 s58, s58, 18
    s_add_u32 s57, s57, s58
    s_and_b32 s58, s44, 1
    s_lshl_b32 s58, s58, 11
    s_add_u32 s69, s57, s58
    v_lshrrev_b32 v16, 1, v14
    v_and_b32 v16, 8, v16
    v_xor_b32 v16, v16, v14
    v_lshlrev_b32 v57, 4, v16
    v_and_b32 v16, 32, v14
    v_lshl_add_u32 v59, v16, 4, v57
    s_lshl_b32 s57, s51, 2
    s_add_u32 s57, s57, s44
    s_lshl_b32 s57, s57, 5
    s_sub_u32 s57, s57, 16
    v_add_u32 v16, s57, v14
    v_max_i32 v16, 0, v16
    v_lshlrev_b32 v60, 2, v16
    s_mul_i32 s57, s44, 12288
    s_add_u32 s57, s57, 102400
    v_lshrrev_b32 v16, 2, v14
    v_bfe_u32 v17, v14, 1, 1
    v_mul_u32_u24 v17, 24, v17
    v_xor_b32 v16, v16, v17
    v_and_b32 v17, 1, v14
    v_lshlrev_b32 v17, 3, v17
    v_lshl_add_u32 v16, v16, 4, v17
    v_add_u32 v58, s57, v16
    v_add_u32 v49, 75776, v16
    v_add_u32 v11, 48384, v1
    v_and_b32 v16, 15, v14
    v_subrev_u32 v17, 12, v16
    v_min_u32 v16, v16, v17
    v_add_u32 v17, 12, v16
    v_xor_b32 v17, v17, v14
    v_bfe_u32 v17, v17, 4, 1
    v_mad_u32_u24 v16, v17, 12, v16
    v_lshrrev_b32 v17, 5, v14
    v_mad_u32_u24 v16, v17, 24, v16
    v_lshlrev_b32 v16, 4, v16
    v_add_u32 v56, 3072, v16
    s_lshr_b32 s57, s44, 1
    s_add_u32 s57, s57, 1
    s_lshl_b32 s58, s57, 10
    s_mul_i32 s57, s57, 768
    v_add_u32 v16, s58, v1
    v_add_u32 v17, s57, v56
    s_bitcmp1_b32 s44, 0
    s_cselect_b64 s[78:79], -1, 0
    v_cndmask_b32 v12, v16, v17, s[78:79]
    v_add_u32 v13, 48384, v12
    s_mov_b32 s70, 0xaaaaaaaa
    s_mov_b32 s71, 0xaaaaaaaa
    s_mov_b32 s72, 0xfff0ffff
    s_mov_b32 s73, 0xf000ff00
    s_mov_b32 s74, 0xffc0fffc
    s_mov_b32 s75, 0xc000fc00
    v_mov_b32 v16, 0xffff
    v_mov_b32 v17, 0xffff0000
    v_cndmask_b32 v16, v16, v17, s[70:71]
    v_cndmask_b32 v240, v16, v15, s[72:73]
    v_cndmask_b32 v241, v16, v15, s[74:75]
    v_cndmask_b32 v242, v15, v16, s[72:73]
    v_cndmask_b32 v243, v15, v16, s[74:75]
    s_or_b32 s57, s51, s44
    s_cmp_eq_u32 s57, 0
    s_cselect_b32 s57, 0xf149f2ca, 0
    v_mov_b32 v244, s57
    v_mov_b32 v245, s57
    v_mov_b32 v246, s57
    v_mov_b32 v247, s57
    v_and_b32 v18, 15, v14
    v_lshlrev_b32 v53, 2, v18
    v_lshrrev_b32 v16, 4, v14
    v_lshlrev_b32 v16, 4, v16
    v_and_b32 v17, 1, v14
    v_lshl_add_u32 v16, v17, 2, v16
    v_add_u32 v17, 64, v16
    v_cndmask_b32 v54, v16, v17, s[72:73]
    v_cndmask_b32 v55, v16, v17, s[74:75]
    s_lshl_b32 s57, s44, 11
    s_add_u32 s57, s57, 151552
    v_add_u32 v50, s57, v1
    s_lshr_b32 s57, s44, 1
    s_lshl_b32 s57, s57, 10
    s_and_b32 s58, s44, 1
    s_lshl_b32 s58, s58, 3
    s_add_u32 s57, s57, s58
    s_add_u32 s57, s57, 151552
    v_add_u32 v51, s57, v1
    s_lshl_b32 s57, s51, 2
    s_add_u32 s57, s57, s44
    s_mul_i32 s57, s57, 34816
    s_lshl_b32 s58, s52, 10
    s_add_u32 s57, s57, s58
    s_add_u32 s23, s57, 9437184
    s_add_u32 s63, s23, 17408
    s_cmp_lt_u32 s44, 2
    s_cselect_b64 s[78:79], -1, 0
    s_lshl_b32 s57, s55, 2
    s_add_u32 s59, s57, s44
    s_lshl_b32 s58, s54, 7
    s_mul_i32 s57, s59, 14336
    s_add_u32 s56, s57, s58
    s_mul_i32 s57, s44, 100352
    s_add_u32 s22, s57, s58
    s_mul_i32 s21, s44, 14336
    s_mul_i32 s57, s59, 17408
    s_add_u32 s47, s57, 9437184
    s_mul_i32 s58, s54, 229376
    s_mul_i32 s57, s44, 14336
    s_add_u32 s58, s58, s57
    s_add_u32 s68, s58, 7340032
    v_lshrrev_b32 v16, 3, v14
    v_and_b32 v17, 6, v16
    v_and_b32 v19, 7, v14
    v_xor_b32 v17, v17, v19
    v_mul_u32_u24 v16, 896, v16
    v_lshl_add_u32 v52, v17, 4, v16
    v_lshl_add_u32 v0, v19, 4, v16
    s_lshr_b32 s57, s59, 3
    s_lshl_b32 s57, s57, 12
    s_bfe_u32 s58, s59, 0x20001
    s_lshl_b32 s58, s58, 2
    s_add_u32 s57, s57, s58
    s_add_u32 s57, s57, 65664
    v_lshl_add_u32 v127, v18, 8, s57
    s_xor_b32 s57, s44, 0
    s_mul_i32 s57, s57, 12288
    s_add_u32 s57, s57, 98304
    v_add_u32 v120, s57, v1
    s_xor_b32 s57, s44, 1
    s_mul_i32 s57, s57, 12288
    s_add_u32 s57, s57, 98304
    v_add_u32 v121, s57, v1
    s_xor_b32 s57, s44, 2
    s_mul_i32 s57, s57, 12288
    s_add_u32 s57, s57, 98304
    v_add_u32 v122, s57, v1
    s_xor_b32 s57, s44, 3
    s_mul_i32 s57, s57, 12288
    s_add_u32 s57, s57, 98304
    v_add_u32 v123, s57, v1
    s_mul_i32 s64, s44, 12288
    s_add_u32 s64, s64, 102400
    s_mul_i32 s58, s44, 1835008
    s_lshl_b32 s57, s55, 7
    s_add_u32 s57, s57, s58
    v_lshrrev_b32 v16, 3, v14
    v_and_b32 v17, 6, v16
    v_and_b32 v19, 7, v14
    v_xor_b32 v17, v17, v19
    v_lshl_add_u32 v17, v17, 4, s57
    v_mul_u32_u24 v16, 4096, v16
    v_add_u32 v2, v16, v17
    v_add_u32 v3, 31744, v2
    v_add_u32 v4, 63488, v2
    v_add_u32 v5, 95232, v2
    v_lshrrev_b32 v16, 2, v14
    v_bfe_u32 v17, v14, 3, 2
    v_xor_b32 v17, s44, v17
    v_lshlrev_b32 v16, 7, v16
    v_and_b32 v19, 3, v14
    v_lshl_add_u32 v16, v19, 3, v16
    v_add_u32 v16, s64, v16
    v_xor_b32 v19, 0, v17
    v_lshl_add_u32 v6, v19, 5, v16
    v_xor_b32 v19, 1, v17
    v_lshl_add_u32 v7, v19, 5, v16
    v_xor_b32 v19, 2, v17
    v_lshl_add_u32 v8, v19, 5, v16
    v_xor_b32 v19, 3, v17
    v_lshl_add_u32 v9, v19, 5, v16
    v_lshrrev_b32 v16, 1, v14
    v_min_u32 v16, 6, v16
    s_mul_i32 s57, s44, 7
    v_add_u32 v16, s57, v16
    v_mul_u32_u24 v16, 7, v16
    v_add_u32 v16, s54, v16
    v_mul_u32_u24 v17, 2675, v16
    v_lshrrev_b32 v17, 16, v17
    v_mul_u32_u24 v18, 49, v17
    v_add_u32 v18, 1, v18
    v_lshrrev_b32 v18, 1, v18
    v_sub_u32 v16, v16, v18
    v_lshl_add_u32 v16, v16, 3, v17
    v_lshlrev_b32 v16, 8, v16
    v_and_b32 v17, 1, v14
    v_lshl_add_u32 v16, v17, 3, v16
    v_add_u32 v62, 65536, v16
    s_waitcnt vmcnt(2)
    v_min3_u32 v20, v20, v21, v22
    v_min_u32 v20, v20, v23
    v_cmp_eq_u32 vcc, 0, v20
    s_nop 4
    s_cbranch_vccnz L_spin_11
L_go_12:
    s_mov_b64 exec, 1
    buffer_store_dword v61, v15, s[40:43], s100 offen offset:0 sc1
    s_mov_b64 exec, -1
    s_mov_b32 exec_hi, 0
    s_add_u32 s61, s50, 688128
    buffer_load_dword v125, v32, s[24:27], s61 offen
    s_mov_b64 exec, -1
    buffer_load_dwordx4 v[24:27], v39, s[40:43], 0 offen offset:0 sc1
    buffer_load_dwordx4 v[28:31], v39, s[40:43], 0 offen offset:1024 sc1
    s_waitcnt vmcnt(0)
    v_min3_u32 v24, v24, v25, v26
    v_min3_u32 v24, v24, v27, v28
    v_min3_u32 v24, v24, v29, v30
    v_min_u32 v24, v24, v31
    v_cmp_eq_u32 vcc, 0, v24
    s_nop 4
    s_cbranch_vccnz L_spin_14
L_go_15:
    s_barrier
    buffer_load_dword v60, v60, s[40:43], 0 offen offset:0 sc1
    buffer_load_dword v40, v63, s[40:43], 0 offen sc1
    s_waitcnt vmcnt(1)
    ds_bpermute_b32 v44, v53, v60 offset:64
    ds_bpermute_b32 v45, v53, v60 offset:128
    ds_bpermute_b32 v252, v54, v60
    ds_bpermute_b32 v253, v55, v60 offset:8
    ds_bpermute_b32 v254, v54, v60 offset:64
    ds_bpermute_b32 v255, v55, v60 offset:72
    s_waitcnt lgkmcnt(0)
    v_mul_f32 v44, 0x3e8b97f6, v44
    v_mul_f32 v45, 0x3e8b97f6, v45
    v_mul_f32 v248, v44, v252
    v_mul_f32 v249, v44, v253
    v_mul_f32 v250, v45, v254
    v_mul_f32 v251, v45, v255
    v_add_u32 v60, 48384, v56
    v_cndmask_b32 v53, v1, v59, s[78:79]
    v_subrev_u32 v54, 48, v14
    v_ashrrev_i32 v54, 31, v54
    s_waitcnt vmcnt(0)
    v_or_b32 v40, s44, v40
    v_cmp_eq_u32 vcc, 0, v40
    s_nop 4
    s_cbranch_vccnz L_spin_18
L_go_19:
    s_barrier
    s_add_u32 m0, s9, 0
    s_add_u32 s60, s69, 0
    buffer_load_dwordx4 v59, s[40:43], s60 offen offset:0 sc1 lds
    s_add_u32 m0, s9, 4096
    s_add_u32 s60, s69, 524288
    buffer_load_dwordx4 v59, s[40:43], s60 offen offset:0 sc1 lds
    s_add_u32 m0, s9, 8192
    s_add_u32 s60, s69, 1048576
    buffer_load_dwordx4 v59, s[40:43], s60 offen offset:0 sc1 lds
    s_mov_b32 m0, s10
    s_mov_b32 s60, s11
    buffer_load_dwordx4 v53, s[40:43], s60 offen offset:0 sc1 lds
    s_add_u32 m0, s8, 0
    s_add_u32 s60, s67, 0
    buffer_load_dwordx4 v1, s[40:43], s60 offen offset:0 sc1 lds
    buffer_load_dwordx4 v1, s[40:43], s60 offen offset:1024 sc1 lds
    buffer_load_dwordx4 v1, s[40:43], s60 offen offset:2048 sc1 lds
    buffer_load_dwordx4 v1, s[40:43], s60 offen offset:3072 sc1 lds
    s_add_u32 m0, s8, 4096
    s_add_u32 s60, s67, 4096
    buffer_load_dwordx4 v1, s[40:43], s60 offen offset:0 sc1 lds
    buffer_load_dwordx4 v1, s[40:43], s60 offen offset:1024 sc1 lds
    buffer_load_dwordx4 v1, s[40:43], s60 offen offset:2048 sc1 lds
    buffer_load_dwordx4 v1, s[40:43], s60 offen offset:3072 sc1 lds
    s_add_u32 m0, s8, 8192
    s_add_u32 s60, s67, 8192
    buffer_load_dwordx4 v1, s[40:43], s60 offen offset:0 sc1 lds
    buffer_load_dwordx4 v1, s[40:43], s60 offen offset:1024 sc1 lds
    buffer_load_dwordx4 v1, s[40:43], s60 offen offset:2048 sc1 lds
    buffer_load_dwordx4 v1, s[40:43], s60 offen offset:3072 sc1 lds
    s_add_u32 m0, s8, 12288
    s_add_u32 s60, s67, 12288
    buffer_load_dwordx4 v1, s[40:43], s60 offen offset:0 sc1 lds
    buffer_load_dwordx4 v1, s[40:43], s60 offen offset:1024 sc1 lds
    buffer_load_dwordx4 v1, s[40:43], s60 offen offset:2048 sc1 lds
    buffer_load_dwordx4 v1, s[40:43], s60 offen offset:3072 sc1 lds
    s_add_u32 m0, s8, 16384
    s_add_u32 s60, s67, 16384
    buffer_load_dwordx4 v1, s[40:43], s60 offen offset:0 sc1 lds
    buffer_load_dwordx4 v1, s[40:43], s60 offen offset:1024 sc1 lds
    s_cmp_lt_u32 s53, 4
    s_cbranch_scc0 L_fast
    s_add_u32 s60, s3, 0
    s_add_u32 m0, s64, 0
    s_nop 0
    buffer_load_dwordx4 v57, s[40:43], s60 offen offset:0 sc1 lds
    buffer_load_dwordx4 v57, s[40:43], s60 offen offset:1024 sc1 lds
    buffer_load_dwordx4 v57, s[40:43], s60 offen offset:2048 sc1 lds
    buffer_load_dwordx4 v57, s[40:43], s60 offen offset:3072 sc1 lds
    s_add_u32 s60, s3, 262144
    s_add_u32 m0, s64, 4096
    s_nop 0
    buffer_load_dwordx4 v57, s[40:43], s60 offen offset:0 sc1 lds
    buffer_load_dwordx4 v57, s[40:43], s60 offen offset:1024 sc1 lds
    buffer_load_dwordx4 v57, s[40:43], s60 offen offset:2048 sc1 lds
    buffer_load_dwordx4 v57, s[40:43], s60 offen offset:3072 sc1 lds
    s_waitcnt vmcnt(0) lgkmcnt(0)
    s_branch L_join
L_spin_21:
    s_mov_b32 s65, 0
L_retry_23:
    s_sleep 8
    buffer_load_dwordx2 v[124:125], v62, s[40:43], 0 offen sc1
    s_waitcnt vmcnt(0)
    v_min_u32 v124, v124, v125
    v_cmp_eq_u32 vcc, 0, v124
    s_add_u32 s65, s65, 1
    s_cmp_gt_u32 s65, 0x20000
    s_nop 1
    s_cbranch_scc1 L_go_22
    s_cbranch_vccnz L_retry_23
    s_branch L_go_22
L_spin_24:
    s_mov_b32 s65, 0
L_retry_26:
    s_sleep 8
    buffer_load_dword v63, v127, s[40:43], 0 offen sc1
    s_waitcnt vmcnt(0)
    v_cmp_eq_u32 vcc, 0, v63
    s_add_u32 s65, s65, 1
    s_cmp_gt_u32 s65, 0x20000
    s_nop 1
    s_cbranch_scc1 L_go_25
    s_cbranch_vccnz L_retry_26
    s_branch L_go_25
L_code_end:
.section .rodata,"a"
.p2align 6
.amdhsa_kernel recurrent_scan__sliding_local_dilated__mixer_token_mlp__prompt_kernel
  .amdhsa_next_free_vgpr 512
  .amdhsa_next_free_sgpr 102
  .amdhsa_accum_offset 256
  .amdhsa_group_segment_fixed_size 0
  .amdhsa_kernarg_size 88
  .amdhsa_user_sgpr_count 2
  .amdhsa_user_sgpr_kernarg_segment_ptr 1
  .amdhsa_system_sgpr_workgroup_id_x 1
  .amdhsa_float_denorm_mode_32 3
.end_amdhsa_kernel
```
